```python
import torch

def _softmax(x, axis=-1):
    return torch.softmax(x, dim=axis)
def _gelu(x):
    return torch.nn.functional.gelu(x, approximate="tanh")
def _silu(x):
    return torch.nn.functional.silu(x)
def _sigmoid(x):
    return torch.sigmoid(x)
def _layernorm(x, axis=-1, eps=1e-5):
    m = x.mean(dim=axis, keepdim=True)
    v = x.var(dim=axis, keepdim=True, unbiased=False)
    return (x - m) / torch.sqrt(v + eps)
def _scatter_add(tgt, idx, src, axis=0):
    return tgt.clone().index_add_(axis, idx, src)
def _segment_sum(src, seg, n):
    out = torch.zeros((n,) + src.shape[1:], dtype=src.dtype)
    return out.index_add_(0, seg, src)
def _pad(x, pw):
    flat = tuple(v for pair in reversed(pw) for v in pair)
    return torch.nn.functional.pad(x, flat)

kernel_name = 'standalone__deep_cross_pnn__recsys'

def setup_inputs():

    _w = (lambda a: (lambda t: t.to(torch.bfloat16) if t.is_floating_point() else t)(torch.as_tensor(a)))
    B, F, D, V = 16384, 26, 64, min(1000, 100000)
    H = 4 * D
    return {
        "idx": _w((lambda lo, hi, *s: torch.randint(lo, hi, s))(0, V, B, F).to(torch.int64)),
        "table": _w((lambda *s: torch.randn(*s, dtype=torch.bfloat16) * 3.2)(V, D) * (D ** -0.5)),
        "w_p": _w((lambda *s: torch.randn(*s, dtype=torch.bfloat16) * 0.05)(F * F) * ((F * F) ** -0.5)),
        "w1": _w((lambda *s: torch.randn(*s, dtype=torch.bfloat16) * 3.2)(F * D, H) * ((F * D) ** -0.5)),
        "b1": _w((lambda *s: torch.randn(*s, dtype=torch.bfloat16) * 3.2)(H) * 0.01),
        "w2": _w((lambda *s: torch.randn(*s, dtype=torch.bfloat16) * 0.05)(H) * (H ** -0.5)),
        "b2": _w((lambda *s: torch.randn(*s, dtype=torch.bfloat16) * 0.05)(1) * 0.01),
    }

def reference(idx, table, w_p, w1, b1, w2, b2):
    emb = table[idx]
    B = emb.shape[0]; F = emb.shape[1]; D = emb.shape[2]
    ip = torch.einsum('bid,bjd->bij', emb, emb)
    ip = ip.reshape(B, F * F)
    logit_p = ip @ w_p
    z = emb.reshape(B, F * D)
    h = _gelu(z @ w1 + b1)
    logit_d = h @ w2 + b2
    return logit_p + logit_d
```

```asm
; @launch grid=(256,1,1) block=(256,1,1) lds=157696
.amdgcn_target "amdgcn-amd-amdhsa--gfx950"
.text
.globl standalone__deep_cross_pnn__recsys_kernel
.p2align 8
.type standalone__deep_cross_pnn__recsys_kernel,@function
standalone__deep_cross_pnn__recsys_kernel:
    s_load_dwordx2 s[8:9], s[0:1], 8
    s_cmp_ge_u32 s2, 256
    s_cbranch_scc1 L_end
    v_lshrrev_b32 v2, 6, v0
    v_and_b32_e64 v1, 63, v0
    s_lshr_b32 s43, s2, 3
    v_readfirstlane_b32 s40, v2
    s_lshl_b32 s58, s43, 2
    s_getpc_b64 s[52:53]
L_pc:
    s_add_u32 s58, s58, s40
    s_and_b32 s56, s58, 63
    s_lshl_b32 s56, s56, 7
    s_addk_i32 s56, 4096
    s_min_u32 s56, s56, L_end-L_pc
    v_mov_b32 v248, s56
    s_mul_i32 s56, s40, 1024
    v_lshl_add_u32 v249, v1, 7, s56
    v_cmp_gt_u32 vcc, 8, v1
    s_nop 1
    v_cndmask_b32 v248, v248, v249, vcc
    s_lshl_b32 s56, s40, 12
    s_addk_i32 s56, 3328
    s_min_u32 s56, s56, L_end-L_pc
    v_writelane_b32 v248, s56, 63
    global_load_dword v249, v248, s[52:53]
    s_mov_b32 s10, 128000
    s_mov_b32 s11, 0x20000
    v_lshlrev_b32 v33, 4, v1
    s_movk_i32 s50, 1040
    s_movk_i32 s57, 127
    s_mul_i32 m0, s58, s50
    s_lshl_b32 s51, s58, 10
    s_waitcnt lgkmcnt(0)
    buffer_load_dwordx4 v33, s[8:11], s51 offen lds
    s_add_u32 s58, s58, 4
    s_and_b32 s58, s58, s57
    s_mul_i32 m0, s58, s50
    s_lshl_b32 s51, s58, 10
    s_load_dwordx2 s[20:21], s[0:1], 32
    s_load_dwordx2 s[24:25], s[0:1], 40
    s_load_dwordx2 s[12:13], s[0:1], 16
    s_load_dwordx2 s[28:29], s[0:1], 48
    s_load_dwordx2 s[4:5], s[0:1], 0
    s_load_dwordx2 s[16:17], s[0:1], 24
    s_load_dwordx2 s[36:37], s[0:1], 72
    s_mov_b32 s22, 512
    s_mov_b32 s23, 0x20000
    s_mov_b32 s14, 1352
    s_mov_b32 s15, 0x20000
    s_mov_b32 s30, 2
    s_mov_b32 s31, 0x20000
    s_bfe_u32 s92, s2, 0x10003
    buffer_load_dwordx4 v33, s[8:11], s51 offen lds
    s_add_u32 s58, s58, 4
    s_and_b32 s58, s58, s57
    s_mul_i32 m0, s58, s50
    s_lshl_b32 s51, s58, 10
    s_lshl_b32 s47, s92, 8
    v_and_b32 v25, 3, v0
    v_lshlrev_b32 v25, 4, v25
    v_bfe_u32 v26, v0, 2, 3
    v_lshl_or_b32 v25, v26, 1, v25
    v_and_b32 v26, 0x60, v0
    v_lshl_or_b32 v25, v26, 1, v25
    buffer_load_dwordx4 v33, s[8:11], s51 offen lds
    s_add_u32 s58, s58, 4
    s_and_b32 s58, s58, s57
    s_mul_i32 m0, s58, s50
    s_lshl_b32 s51, s58, 10
    v_or_b32 v25, s47, v25
    v_mov_b32 v26, 0
    v_mov_b32_e64 v13, 0
    s_and_b32 s42, s40, 1
    s_lshl_b32 s47, s42, 10
    s_waitcnt lgkmcnt(0)
    s_cmp_ge_u32 s40, 2
    s_cselect_b64 s[20:21], s[24:25], s[20:21]
    s_cbranch_scc1 L_nowp
    s_add_u32 m0, s47, 153600
    s_nop 0
    buffer_load_dwordx4 v33, s[12:15], s47 offen lds
    s_mul_i32 m0, s58, s50
L_nowp:
    buffer_load_short_d16_hi v26, v25, s[20:23], 0 offen
    buffer_load_short_d16_hi v13, off, s[28:31], 0
    buffer_load_dwordx4 v33, s[8:11], s51 offen lds
    s_add_u32 s58, s58, 4
    s_and_b32 s58, s58, s57
    s_mul_i32 m0, s58, s50
    s_lshl_b32 s51, s58, 10
    s_mov_b32 s56, 4
L_tab:
    buffer_load_dwordx4 v33, s[8:11], s51 offen lds
    s_add_u32 s58, s58, 4
    s_and_b32 s58, s58, s57
    s_mul_i32 m0, s58, s50
    s_lshl_b32 s51, s58, 10
    buffer_load_dwordx4 v33, s[8:11], s51 offen lds
    s_add_u32 s58, s58, 4
    s_and_b32 s58, s58, s57
    s_mul_i32 m0, s58, s50
    s_lshl_b32 s51, s58, 10
    buffer_load_dwordx4 v33, s[8:11], s51 offen lds
    s_add_u32 s58, s58, 4
    s_and_b32 s58, s58, s57
    s_mul_i32 m0, s58, s50
    s_lshl_b32 s51, s58, 10
    buffer_load_dwordx4 v33, s[8:11], s51 offen lds
    s_add_u32 s58, s58, 4
    s_and_b32 s58, s58, s57
    s_mul_i32 m0, s58, s50
    s_lshl_b32 s51, s58, 10
    s_sub_u32 s56, s56, 1
    s_cmp_lg_u32 s56, 0
    s_cbranch_scc1 L_tab
    buffer_load_dwordx4 v33, s[8:11], s51 offen lds
    s_add_u32 s58, s58, 4
    s_and_b32 s58, s58, s57
    s_mul_i32 m0, s58, s50
    s_lshl_b32 s51, s58, 10
    s_mov_b32 s6, 1703936
    s_mov_b32 s7, 0x20000
    s_lshr_b32 s96, s2, 4
    s_lshl_b32 s96, s96, 3
    s_and_b32 s47, s2, 7
    s_or_b32 s96, s96, s47
    s_lshl2_add_u32 s96, s96, s40
    s_mul_i32 s59, s96, 3328
    v_cmp_gt_u32 vcc, 16, v1
    v_add_u32 v28, 3072, v33
    buffer_load_dwordx4 v33, s[8:11], s51 offen lds
    s_add_u32 s58, s58, 4
    s_and_b32 s58, s58, s57
    s_mul_i32 m0, s58, s50
    s_lshl_b32 s51, s58, 10
    s_lshr_b32 s41, s40, 1
    v_cndmask_b32 v28, -1, v28, vcc
    s_mov_b32 s18, 851968
    s_mov_b32 s19, 0x20000
    s_lshr_b32 s43, s2, 4
    s_cmp_ge_u32 s43, 13
    s_cselect_b32 s47, 13, 0
    s_sub_u32 s43, s43, s47
    v_lshrrev_b32_e64 v30, 4, v1
    buffer_load_dwordx4 v33, s[8:11], s51 offen lds
    s_add_u32 s58, s58, 4
    s_and_b32 s58, s58, s57
    s_mul_i32 m0, s58, s50
    s_lshl_b32 s51, s58, 10
    v_lshlrev_b32_e64 v2, 12, v30
    v_and_b32 v31, 15, v1
    v_lshl_or_b32 v2, v31, 4, v2
    s_lshl_b32 s47, s92, 8
    v_or_b32 v2, s47, v2
    v_add_u32 v3, 0x4000, v2
    s_mul_i32 s44, s42, 425984
    s_lshl_b32 s43, s43, 15
    s_add_u32 s43, s43, s44
    buffer_load_dwordx4 v33, s[8:11], s51 offen lds
    s_add_u32 s58, s58, 4
    s_and_b32 s58, s58, s57
    s_mul_i32 m0, s58, s50
    s_lshl_b32 s51, s58, 10
    s_mov_b32 s54, s43
    buffer_load_dwordx4 v33, s[8:11], s51 offen lds
    s_add_u32 s58, s58, 4
    s_and_b32 s58, s58, s57
    s_mul_i32 m0, s58, s50
    s_lshl_b32 s51, s58, 10
    s_load_dwordx2 s[32:33], s[0:1], 56
    s_mov_b32 s38, 16777216
    s_mov_b32 s39, 0x20000
    s_lshl_b32 s95, s96, 11
    s_add_u32 s95, s95, 2098176
    s_add_u32 s93, s40, s41
    s_mul_i32 s93, s93, 3328
    s_add_u32 s93, s93, 133120
    v_add_u32_e64 v24, s93, v33
    buffer_load_dwordx4 v33, s[8:11], s51 offen lds
    s_add_u32 s58, s58, 4
    s_and_b32 s58, s58, s57
    s_mul_i32 m0, s58, s50
    s_lshl_b32 s51, s58, 10
    s_mov_b32 s34, 32768
    s_mov_b32 s35, 0x20000
    s_mov_b32 s48, 0x05040100
    s_mov_b32 s49, 0x07060302
    s_mov_b32 s55, 0x7ff00000
    s_mov_b32 s56, 6
    v_lshlrev_b32 v12, 4, v30
    s_add_u32 s45, s44, 425984
    s_mov_b32 s46, s43
    buffer_load_dwordx4 v33, s[8:11], s51 offen lds
    s_add_u32 s58, s58, 4
    s_and_b32 s58, s58, s57
    s_mul_i32 m0, s58, s50
    s_lshl_b32 s51, s58, 10
    v_mul_u32_u24 v32, 104, v31
    s_mul_i32 s47, s92, 1664
    s_add_u32 s97, s93, s47
    v_add_u32 v11, s97, v32
    s_sub_u32 s47, s93, s47
    s_add_u32 s47, s47, 1664
    v_add_u32 v10, s47, v32
    v_min_u32 v32, 12, v31
    v_lshlrev_b32_e64 v15, 2, v32
    buffer_load_dwordx4 v33, s[8:11], s51 offen lds
    s_add_u32 s58, s58, 4
    s_and_b32 s58, s58, s57
    s_mul_i32 m0, s58, s50
    s_lshl_b32 s51, s58, 10
    v_add_u32_e64 v15, s97, v15
    v_mul_u32_u24 v18, 208, v30
    v_lshl_add_u32 v18, v31, 1, v18
    v_add_u32 v18, 153600, v18
    v_mul_u32_u24_e64 v19, 52, v31
    v_lshl_add_u32 v19, v30, 3, v19
    v_add_u32 v19, 154276, v19
    v_lshlrev_b32_e64 v14, 3, v12
    v_add_u32 v14, 155648, v14
    buffer_load_dwordx4 v33, s[8:11], s51 offen lds
    s_add_u32 s58, s58, 4
    s_and_b32 s58, s58, s57
    s_mul_i32 m0, s58, s50
    s_lshl_b32 s51, s58, 10
    v_mov_b32 v36, 0
    v_mov_b32 v37, 0
    v_mov_b32 v38, 0
    v_mov_b32 v39, 0
    v_mov_b32 v40, 0
    v_mov_b32 v41, 0
    v_mov_b32 v42, 0
    v_mov_b32 v43, 0
    v_mov_b32_e64 v44, 0
    buffer_load_dwordx4 v33, s[8:11], s51 offen lds
    s_add_u32 s58, s58, 4
    s_and_b32 s58, s58, s57
    s_mul_i32 m0, s58, s50
    s_lshl_b32 s51, s58, 10
    v_mov_b32 v45, 0
    v_mov_b32 v46, 0
    v_mov_b32 v47, 0
    v_mov_b32 v240, 0
    v_mov_b32 v241, 0
    v_mov_b32 v242, 0
    v_mov_b32 v243, 0
    s_nop 1
    v_mfma_f32_32x32x16_bf16 a[64:79], v[240:243], v[240:243], 0
    buffer_load_dwordx4 v33, s[8:11], s51 offen lds
    s_add_u32 s58, s58, 4
    s_and_b32 s58, s58, s57
    s_mul_i32 m0, s58, s50
    s_lshl_b32 s51, s58, 10
    v_mfma_f32_32x32x16_bf16 a[80:95], v[240:243], v[240:243], 0
    v_mfma_f32_32x32x16_bf16 a[96:111], v[240:243], v[240:243], 0
    v_mfma_f32_32x32x16_bf16 a[112:127], v[240:243], v[240:243], 0
    buffer_load_dwordx4 v33, s[8:11], s51 offen lds
    buffer_load_dwordx4 v[224:227], v33, s[4:7], s59 offen offset:0 nt
    buffer_load_dwordx4 v[228:231], v33, s[4:7], s59 offen offset:1024 nt
    buffer_load_dwordx4 v[232:235], v33, s[4:7], s59 offen offset:2048 nt
    buffer_load_dwordx4 v[236:239], v28, s[4:7], s59 offen nt
    buffer_load_dwordx4 v[48:51], v2, s[16:19], s54 offen offset:0
    s_lshr_b32 s57, s43, 13
    v_add_u32 v8, s57, v10
    v_add_u32 v9, s57, v11
    v_lshlrev_b32 v25, 2, v0
    v_add_u32 v23, 130000, v25
    v_add_u32 v25, 155648, v25
    ds_write_b32 v23, v240
    s_waitcnt vmcnt(35)
    ds_write_b32 v25, v26
    v_cmp_lt_u32 vcc, 12, v31
    v_cmp_eq_u32 s[52:53], 3, v30
    s_lshl_b32 s47, s40, 8
    s_add_u32 s47, s47, 156672
    s_or_b64 s[52:53], s[52:53], vcc
    s_waitcnt lgkmcnt(0)
    s_barrier
    buffer_load_dwordx4 v[52:55], v2, s[16:19], s54 offen offset:512
    ds_read_u16_d16_hi v36, v18 offset:0
    ds_read_u16_d16_hi v40, v18 offset:26
    ds_read_u16_d16_hi v44, v18 offset:702
    ds_read_u16_d16_hi v240, v19 offset:0
    ds_read_u16_d16_hi v37, v18 offset:52
    ds_read_u16_d16_hi v41, v18 offset:78
    ds_read_u16_d16_hi v45, v18 offset:754
    ds_read_u16_d16_hi v241, v19 offset:2
    ds_read_u16_d16_hi v38, v18 offset:104
    ds_read_u16_d16_hi v42, v18 offset:130
    ds_read_u16_d16_hi v46, v18 offset:806
    ds_read_u16_d16_hi v242, v19 offset:4
    buffer_load_dwordx4 v[56:59], v2, s[16:19], s54 offen offset:1024
    ds_read_u16_d16_hi v39, v18 offset:156
    ds_read_u16_d16_hi v43, v18 offset:182
    ds_read_u16_d16_hi v47, v18 offset:858
    ds_read_u16_d16_hi v243, v19 offset:6
    ds_read_b128 a[0:3], v14 offset:0
    ds_read_b128 a[32:35], v14 offset:0
    ds_read_b128 a[4:7], v14 offset:16
    ds_read_b128 a[36:39], v14 offset:16
    ds_read_b128 a[8:11], v14 offset:32
    ds_read_b128 a[40:43], v14 offset:32
    ds_read_b128 a[12:15], v14 offset:48
    ds_read_b128 a[44:47], v14 offset:48
    buffer_load_dwordx4 v[60:63], v2, s[16:19], s54 offen offset:1536
    ds_read_b128 a[16:19], v14 offset:64
    ds_read_b128 a[48:51], v14 offset:64
    ds_read_b128 a[20:23], v14 offset:80
    ds_read_b128 a[52:55], v14 offset:80
    ds_read_b128 a[24:27], v14 offset:96
    ds_read_b128 a[56:59], v14 offset:96
    ds_read_b128 a[28:31], v14 offset:112
    ds_read_b128 a[60:63], v14 offset:112
    s_waitcnt lgkmcnt(15)
    v_add_f32 v40, v40, v240
    v_add_f32 v41, v41, v241
    v_add_f32 v42, v42, v242
    v_add_f32_e64 v43, v43, v243
    v_cndmask_b32 v36, v36, 0, vcc
    buffer_load_dwordx4 v[64:67], v2, s[16:19], s54 offen offset:2048
    v_cndmask_b32 v37, v37, 0, s[52:53]
    v_cndmask_b32 v38, v38, 0, s[52:53]
    v_cndmask_b32 v39, v39, 0, s[52:53]
    v_cndmask_b32 v40, v40, 0, vcc
    v_cndmask_b32 v41, v41, 0, s[52:53]
    v_cndmask_b32 v42, v42, 0, s[52:53]
    v_cndmask_b32 v43, v43, 0, s[52:53]
    v_cndmask_b32 v44, v44, 0, vcc
    v_cndmask_b32 v45, v45, 0, s[52:53]
    v_cndmask_b32 v46, v46, 0, s[52:53]
    v_cndmask_b32 v47, v47, 0, s[52:53]
    v_add_u32 v23, 130000, v12
    v_cndmask_b32 v22, 16, 0, vcc
    v_cndmask_b32 v23, v12, v23, vcc
    v_lshlrev_b32 v0, 2, v30
    v_add_u32_e64 v0, s47, v0
    s_mov_b32 s52, 0xbdd2d3e8
    buffer_load_dwordx4 v[68:71], v2, s[16:19], s54 offen offset:2560
    s_mov_b32 s53, 0xc0135761
    ds_read_b128 v[240:243], v14 offset:608
    ds_read_b128 v[244:247], v14 offset:624
    s_lshl1_add_u32 s58, s96, s92
    s_lshl_b32 s58, s58, 5
    s_lshl_b32 s93, s92, 9
    s_add_u32 s93, s93, s95
    s_sub_u32 s93, s93, 1024
    s_getreg_b32 s96, hwreg(HW_REG_XCC_ID, 0, 3)
    s_mov_b32 s94, 532480
    buffer_load_dwordx4 v[72:75], v2, s[16:19], s54 offen offset:3072
    buffer_load_dwordx4 v[76:79], v2, s[16:19], s54 offen offset:3584
    s_cmp_eq_u32 s40, 1
    s_mov_b64 exec, 0
    s_cbranch_scc1 L_pt1
    s_cmp_eq_u32 s40, 2
    s_cbranch_scc1 L_pt2
    s_branch L_pt0
L_ptb:
    s_mov_b64 exec, -1
    buffer_load_dwordx4 v[80:83], v3, s[16:19], s54 offen offset:0
    buffer_load_dwordx4 v[84:87], v3, s[16:19], s54 offen offset:512
    buffer_load_dwordx4 v[88:91], v3, s[16:19], s54 offen offset:1024
    buffer_load_dwordx4 v[92:95], v3, s[16:19], s54 offen offset:1536
    s_waitcnt vmcnt(15)
    v_mul_u32_u24 v224, s94, v224
    v_mul_u32_u24 v225, s94, v225
    v_mul_u32_u24 v226, s94, v226
    v_mul_u32_u24_e64 v227, s94, v227
    ds_write_b128 v24, v[224:227] offset:0
    s_waitcnt vmcnt(14)
    v_mul_u32_u24 v228, s94, v228
    v_mul_u32_u24 v229, s94, v229
    v_mul_u32_u24 v230, s94, v230
    v_mul_u32_u24_e64 v231, s94, v231
    ds_write_b128 v24, v[228:231] offset:1024
    s_waitcnt vmcnt(13)
    v_mul_u32_u24 v232, s94, v232
    v_mul_u32_u24 v233, s94, v233
    v_mul_u32_u24 v234, s94, v234
    v_mul_u32_u24_e64 v235, s94, v235
    ds_write_b128 v24, v[232:235] offset:2048
    s_waitcnt vmcnt(12)
    v_mul_u32_u24 v236, s94, v236
    v_mul_u32_u24 v237, s94, v237
    v_mul_u32_u24 v238, s94, v238
    v_mul_u32_u24_e64 v239, s94, v239
    s_bfm_b64 exec, 16, 0
    s_cmp_lg_u32 s42, 0
    ds_write_b128 v24, v[236:239] offset:3072
    s_cbranch_scc1 L_nodup
    ds_write_b128 v24, v[236:239] offset:9728
    s_mov_b64 exec, -1
    ds_write_b128 v24, v[224:227] offset:6656
    ds_write_b128 v24, v[228:231] offset:7680
    ds_write_b128 v24, v[232:235] offset:8704
L_nodup:
    s_mov_b64 exec, -1
    s_waitcnt lgkmcnt(0)
    ds_read2_b32 v[176:177], v15 offset0:0 offset1:13
    ds_read2_b32 v[178:179], v15 offset0:26 offset1:39
    ds_read2_b32 v[180:181], v15 offset0:52 offset1:65
    ds_read2_b32 v[182:183], v15 offset0:78 offset1:91
    ds_read2_b32 v[16:17], v15 offset0:104 offset1:117
    s_barrier
    s_xor_b32 s94, s93, 512
    s_waitcnt lgkmcnt(4)
    v_mad_u32_u16 v176, v176, v22, v23 op_sel:[1,0,0,0]
    v_mad_u32_u16 v177, v177, v22, v23 op_sel:[1,0,0,0]
    ds_read_b128 a[208:211], v176 offset:0
    ds_read_b128 a[216:219], v177 offset:0
    ds_read_b128 a[212:215], v176 offset:64
    ds_read_b128 a[220:223], v177 offset:64
    buffer_load_dwordx4 v[96:99], v3, s[16:19], s54 offen offset:2048
    s_waitcnt lgkmcnt(7)
    v_mad_u32_u16 v178, v178, v22, v23 op_sel:[1,0,0,0]
    v_mad_u32_u16 v179, v179, v22, v23 op_sel:[1,0,0,0]
    ds_read_b128 a[224:227], v178 offset:0
    buffer_load_dwordx4 v[100:103], v3, s[16:19], s54 offen offset:2560
    s_waitcnt lgkmcnt(4)
    v_mfma_f32_16x16x32_bf16 v[200:203], a[208:211], a[208:211], 0
    ds_read_b128 a[232:235], v179 offset:0
    buffer_load_dwordx4 v[104:107], v3, s[16:19], s54 offen offset:3072
    ds_read_b128 a[228:231], v178 offset:64
    buffer_load_dwordx4 v[108:111], v3, s[16:19], s54 offen offset:3584
    s_add_u32 s43, s43, 0x8000
    s_cmp_eq_u32 s43, s45
    s_cselect_b32 s43, s44, s43
    s_mov_b32 s54, s43
    s_add_u32 s50, s43, 0x8000
    s_cmp_eq_u32 s50, s45
    s_cselect_b32 s50, s44, s50
    s_mov_b32 s59, s50
    ds_read_b128 a[236:239], v179 offset:64
    s_waitcnt lgkmcnt(5)
    v_mfma_f32_16x16x32_bf16 v[200:203], a[212:215], a[212:215], v[200:203]
    v_mfma_f32_16x16x32_bf16 v[204:207], a[208:211], a[216:219], 0
    s_waitcnt lgkmcnt(4)
    v_mfma_f32_16x16x32_bf16 v[204:207], a[212:215], a[220:223], v[204:207]
    ds_read2st64_b32 v[4:5], v8 offset0:0 offset1:13
    v_mfma_f32_16x16x32_bf16 v[208:211], a[216:219], a[216:219], 0
    v_mfma_f32_16x16x32_bf16 v[208:211], a[220:223], a[220:223], v[208:211]
    s_waitcnt lgkmcnt(4)
    v_mfma_f32_16x16x32_bf16 v[212:215], a[224:227], a[224:227], 0
    ds_read2st64_b32 v[6:7], v9 offset0:0 offset1:13
    v_mul_f32 v21, v200, v36
    v_fmac_f32_e64 v21, v201, v37
    v_mad_u32_u16 v180, v180, v22, v23 op_sel:[1,0,0,0]
    v_mad_u32_u16 v181, v181, v22, v23 op_sel:[1,0,0,0]
    ds_read_b128 a[240:243], v180 offset:0
    s_waitcnt lgkmcnt(4)
    v_mfma_f32_16x16x32_bf16 v[212:215], a[228:231], a[228:231], v[212:215]
    ds_read_b128 a[248:251], v181 offset:0
    ds_read_b128 a[244:247], v180 offset:64
    v_fmac_f32 v21, v202, v38
    v_fmac_f32 v21, v203, v39
    ds_read_b128 a[252:255], v181 offset:64
    v_mfma_f32_16x16x32_bf16 v[216:219], a[224:227], a[232:235], 0
    v_fmac_f32 v21, v204, v40
    v_fmac_f32 v21, v205, v41
    s_waitcnt lgkmcnt(6)
    v_mfma_f32_16x16x32_bf16 v[216:219], a[228:231], a[236:239], v[216:219]
    v_fmac_f32 v21, v206, v42
    v_fmac_f32 v21, v207, v43
    v_mfma_f32_16x16x32_bf16 v[220:223], a[232:235], a[232:235], 0
    v_mad_u32_u16 v182, v182, v22, v23 op_sel:[1,0,0,0]
    v_mad_u32_u16 v183, v183, v22, v23 op_sel:[1,0,0,0]
    ds_read_b128 a[160:163], v182 offset:0
    v_fmac_f32 v21, v208, v44
    v_fmac_f32 v21, v209, v45
    v_mfma_f32_16x16x32_bf16 v[220:223], a[236:239], a[236:239], v[220:223]
    v_fmac_f32 v21, v210, v46
    v_fmac_f32 v21, v211, v47
    s_waitcnt lgkmcnt(4)
    v_mfma_f32_16x16x32_bf16 v[200:203], a[240:243], a[240:243], 0
    ds_read_b128 a[168:171], v183 offset:0
    v_mul_f32 v20, v212, v36
    v_fmac_f32 v20, v213, v37
    s_waitcnt vmcnt(14)
    v_perm_b32 v112, v52, v48, s48
    v_perm_b32 v120, v52, v48, s49
    v_perm_b32 v128, v53, v49, s48
    v_perm_b32 v136, v53, v49, s49
    v_perm_b32 v144, v54, v50, s48
    v_perm_b32 v152, v54, v50, s49
    ds_read_b128 a[164:167], v182 offset:64
    v_perm_b32 v160, v55, v51, s48
    v_perm_b32 v168, v55, v51, s49
    buffer_load_dwordx4 v[48:51], v2, s[16:19], s54 offen offset:0
    s_waitcnt vmcnt(13)
    v_perm_b32 v113, v60, v56, s48
    v_perm_b32 v121, v60, v56, s49
    v_perm_b32 v129, v61, v57, s48
    s_waitcnt lgkmcnt(4)
    v_mfma_f32_16x16x32_bf16 v[200:203], a[244:247], a[244:247], v[200:203]
    ds_read_b128 a[172:175], v183 offset:64
    v_fmac_f32 v20, v214, v38
    v_fmac_f32 v20, v215, v39
    v_mfma_f32_16x16x32_bf16 v[204:207], a[240:243], a[248:251], 0
    buffer_load_dwordx4 v[52:55], v2, s[16:19], s54 offen offset:512
    v_fmac_f32 v20, v216, v40
    v_fmac_f32 v20, v217, v41
    v_mad_u32_u16 v4, v4, 16, v12 op_sel:[1,0,0,0]
    v_mad_u32_u16 v5, v5, 16, v12 op_sel:[1,0,0,0]
    v_mad_u32_u16 v6, v6, 16, v12 op_sel:[1,0,0,0]
    v_mad_u32_u16 v7, v7, 16, v12 op_sel:[1,0,0,0]
    ds_read_b128 a[128:131], v4 offset:0
    s_waitcnt lgkmcnt(5)
    v_mfma_f32_16x16x32_bf16 v[204:207], a[244:247], a[252:255], v[204:207]
    v_fmac_f32 v20, v218, v42
    v_fmac_f32_e64 v20, v219, v43
    v_mfma_f32_16x16x32_bf16 v[208:211], a[248:251], a[248:251], 0
    ds_read_b128 a[132:135], v4 offset:64
    v_fmac_f32 v20, v220, v44
    v_fmac_f32 v20, v221, v45
    v_mfma_f32_16x16x32_bf16 v[208:211], a[252:255], a[252:255], v[208:211]
    v_fmac_f32 v20, v222, v46
    v_fmac_f32 v20, v223, v47
    v_add_f32_dpp v21, v21, v21 row_ror:8 row_mask:0xf bank_mask:0xf
    v_perm_b32 v137, v61, v57, s49
    v_perm_b32 v145, v62, v58, s48
    ds_read_b128 a[136:139], v6 offset:0
    v_add_f32_dpp v21, v21, v21 row_ror:4 row_mask:0xf bank_mask:0xf
    v_perm_b32 v153, v62, v58, s49
    v_perm_b32 v161, v63, v59, s48
    v_add_f32_dpp v21, v21, v21 row_ror:2 row_mask:0xf bank_mask:0xf
    v_perm_b32 v169, v63, v59, s49
    buffer_load_dwordx4 v[56:59], v2, s[16:19], s54 offen offset:1024
    v_add_f32_dpp v21, v21, v21 row_ror:1 row_mask:0xf bank_mask:0xf
    s_waitcnt vmcnt(13)
    v_perm_b32 v114, v68, v64, s48
    v_perm_b32 v122, v68, v64, s49
    ds_read_b128 a[140:143], v6 offset:64
    ds_write_b32 v0, v21 offset:0
    s_waitcnt lgkmcnt(8)
    v_mfma_f32_16x16x32_bf16 v[212:215], a[160:163], a[160:163], 0
    v_mul_f32 v21, v200, v36
    v_fmac_f32 v21, v201, v37
    s_waitcnt lgkmcnt(6)
    v_mfma_f32_16x16x32_bf16 v[212:215], a[164:167], a[164:167], v[212:215]
    buffer_load_dwordx4 v[60:63], v2, s[16:19], s54 offen offset:1536
    v_fmac_f32 v21, v202, v38
    v_fmac_f32 v21, v203, v39
    v_mfma_f32_16x16x32_bf16 v[216:219], a[160:163], a[168:171], 0
    v_fmac_f32 v21, v204, v40
    v_fmac_f32 v21, v205, v41
    s_waitcnt lgkmcnt(5)
    v_mfma_f32_16x16x32_bf16 v[216:219], a[164:167], a[172:175], v[216:219]
    v_fmac_f32 v21, v206, v42
    v_fmac_f32 v21, v207, v43
    v_mfma_f32_16x16x32_bf16 v[220:223], a[168:171], a[168:171], 0
    ds_read_b128 a[144:147], v5 offset:0
    v_fmac_f32 v21, v208, v44
    v_fmac_f32 v21, v209, v45
    v_mfma_f32_16x16x32_bf16 v[220:223], a[172:175], a[172:175], v[220:223]
L_pt0:
    s_cbranch_execz L_ptb
    v_fmac_f32 v21, v210, v46
    v_fmac_f32_e64 v21, v211, v47
    v_add_f32_dpp v20, v20, v20 row_ror:8 row_mask:0xf bank_mask:0xf
    v_perm_b32 v130, v69, v65, s48
    ds_read_b128 a[148:151], v5 offset:64
    v_add_f32_dpp v20, v20, v20 row_ror:4 row_mask:0xf bank_mask:0xf
    v_perm_b32 v138, v69, v65, s49
    v_perm_b32 v146, v70, v66, s48
    v_add_f32_dpp v20, v20, v20 row_ror:2 row_mask:0xf bank_mask:0xf
    v_perm_b32 v154, v70, v66, s49
    v_perm_b32 v162, v71, v67, s48
    v_add_f32_dpp v20, v20, v20 row_ror:1 row_mask:0xf bank_mask:0xf
    v_perm_b32 v170, v71, v67, s49
    buffer_load_dwordx4 v[64:67], v2, s[16:19], s54 offen offset:2048
    ds_read_b128 a[152:155], v7 offset:0
    ds_write_b32 v0, v20 offset:16
    v_add_f32_dpp v21, v21, v21 row_ror:8 row_mask:0xf bank_mask:0xf
    v_mul_f32 v20, v212, v36
    v_fmac_f32 v20, v213, v37
    v_add_f32_dpp v21, v21, v21 row_ror:4 row_mask:0xf bank_mask:0xf
    v_fmac_f32 v20, v214, v38
    v_fmac_f32 v20, v215, v39
    v_add_f32_dpp v21, v21, v21 row_ror:2 row_mask:0xf bank_mask:0xf
    v_fmac_f32 v20, v216, v40
    v_fmac_f32 v20, v217, v41
    buffer_load_dwordx4 v[68:71], v2, s[16:19], s54 offen offset:2560
    ds_read_b128 a[156:159], v7 offset:64
    v_add_f32_dpp v21, v21, v21 row_ror:1 row_mask:0xf bank_mask:0xf
    v_fmac_f32 v20, v218, v42
    v_fmac_f32 v20, v219, v43
    ds_write_b32 v0, v21 offset:32
    v_fmac_f32 v20, v220, v44
    v_fmac_f32 v20, v221, v45
    v_fmac_f32 v20, v222, v46
    v_fmac_f32 v20, v223, v47
    v_add_u32 v0, 48, v0
    s_waitcnt vmcnt(14)
    v_perm_b32 v115, v76, v72, s48
    v_add_f32_dpp v20, v20, v20 row_ror:8 row_mask:0xf bank_mask:0xf
    v_perm_b32 v123, v76, v72, s49
    v_perm_b32 v131, v77, v73, s48
    v_add_f32_dpp v20, v20, v20 row_ror:4 row_mask:0xf bank_mask:0xf
    v_perm_b32 v139, v77, v73, s49
    v_perm_b32 v147, v78, v74, s48
    v_perm_b32 v155, v78, v74, s49
    v_perm_b32 v163, v79, v75, s48
    v_perm_b32 v171, v79, v75, s49
    buffer_load_dwordx4 v[72:75], v2, s[16:19], s54 offen offset:3072
    v_mad_u32_u16 v16, v16, v22, v23 op_sel:[1,0,0,0]
    v_mad_u32_u16 v17, v17, v22, v23 op_sel:[1,0,0,0]
    v_add_u32 v15, 520, v15
    ds_read_b128 a[192:195], v16 offset:0
    ds_read_b128 a[200:203], v17 offset:0
    s_waitcnt vmcnt(13)
    v_perm_b32 v116, v84, v80, s48
    v_perm_b32 v124, v84, v80, s49
    v_perm_b32 v132, v85, v81, s48
    v_perm_b32 v140, v85, v81, s49
    v_perm_b32 v148, v86, v82, s48
    v_perm_b32 v156, v86, v82, s49
    buffer_load_dwordx4 v[76:79], v2, s[16:19], s54 offen offset:3584
    ds_read_b128 a[196:199], v16 offset:64
    ds_read_b128 a[204:207], v17 offset:64
    v_perm_b32 v164, v87, v83, s48
    v_perm_b32 v172, v87, v83, s49
    s_waitcnt vmcnt(12)
    v_perm_b32 v117, v92, v88, s48
    v_perm_b32 v125, v92, v88, s49
    v_perm_b32 v133, v93, v89, s48
    v_perm_b32 v141, v93, v89, s49
    v_perm_b32 v149, v94, v90, s48
    v_perm_b32 v157, v94, v90, s49
    v_perm_b32 v165, v95, v91, s48
    buffer_load_dwordx4 v[80:83], v3, s[16:19], s54 offen offset:0
    v_perm_b32 v173, v95, v91, s49
    s_waitcnt vmcnt(11)
    v_perm_b32 v118, v100, v96, s48
    v_perm_b32 v126, v100, v96, s49
    v_perm_b32 v134, v101, v97, s48
    v_perm_b32 v142, v101, v97, s49
    v_perm_b32 v150, v102, v98, s48
    v_perm_b32 v158, v102, v98, s49
    v_perm_b32 v166, v103, v99, s48
    v_perm_b32 v174, v103, v99, s49
    s_waitcnt vmcnt(9)
    v_perm_b32 v119, v108, v104, s48
    v_perm_b32 v127, v108, v104, s49
    buffer_load_dwordx4 v[84:87], v3, s[16:19], s54 offen offset:512
    v_perm_b32 v135, v109, v105, s48
    v_perm_b32 v143, v109, v105, s49
    v_perm_b32 v151, v110, v106, s48
    v_perm_b32 v159, v110, v106, s49
    v_perm_b32 v167, v111, v107, s48
    v_perm_b32 v175, v111, v107, s49
    s_waitcnt lgkmcnt(5)
    s_nop 0
.p2align 6
L_loop:
    v_mfma_f32_16x16x32_bf16 a[0:3], v[112:115], a[128:131], a[0:3]
    s_waitcnt vmcnt(8)
    v_perm_b32 v176, v52, v48, s48
    v_perm_b32 v184, v52, v48, s49
    v_mfma_f32_16x16x32_bf16 a[0:3], v[116:119], a[132:135], a[0:3]
    buffer_load_dwordx4 v[88:91], v3, s[16:19], s54 offen offset:1024
    v_mfma_f32_16x16x32_bf16 a[32:35], v[116:119], a[140:143], a[32:35]
    s_lshr_b32 s57, s43, 13
    v_perm_b32 v192, v53, v49, s48
    v_perm_b32 v200, v53, v49, s49
    v_mfma_f32_16x16x32_bf16 a[32:35], v[112:115], a[136:139], a[32:35]
    s_waitcnt lgkmcnt(0)
    v_add_u32 v8, s57, v10
    v_add_u32_e64 v9, s57, v11
    v_mfma_f32_16x16x32_bf16 a[64:67], v[112:115], a[144:147], a[64:67]
    v_perm_b32 v208, v54, v50, s48
    v_perm_b32 v216, v54, v50, s49
    v_mfma_f32_16x16x32_bf16 a[64:67], v[116:119], a[148:151], a[64:67]
    buffer_load_dwordx4 v[92:95], v3, s[16:19], s54 offen offset:1536
    v_mfma_f32_16x16x32_bf16 a[96:99], v[116:119], a[156:159], a[96:99]
    v_perm_b32 v224, v55, v51, s48
    v_perm_b32 v232, v55, v51, s49
    v_mfma_f32_16x16x32_bf16 a[96:99], v[112:115], a[152:155], a[96:99]
    ds_read2st64_b32 v[4:5], v8 offset0:0 offset1:13
    v_add_f32_dpp v20, v20, v20 row_ror:2 row_mask:0xf bank_mask:0xf
    v_mfma_f32_16x16x32_bf16 v[24:27], a[192:195], a[192:195], 0
    ds_read2st64_b32 v[6:7], v9 offset0:0 offset1:13
    v_add_f32_dpp v20, v20, v20 row_ror:1 row_mask:0xf bank_mask:0xf
    v_mfma_f32_16x16x32_bf16 v[24:27], a[196:199], a[196:199], v[24:27]
    ds_write_b32 v0, v20 offset:0
    v_mfma_f32_16x16x32_bf16 a[100:103], v[120:123], a[152:155], a[100:103]
    s_waitcnt vmcnt(8)
    v_perm_b32 v177, v60, v56, s48
    v_perm_b32 v185, v60, v56, s49
    v_mfma_f32_16x16x32_bf16 a[100:103], v[124:127], a[156:159], a[100:103]
    buffer_load_dwordx4 v[96:99], v3, s[16:19], s54 offen offset:2048
    v_mfma_f32_16x16x32_bf16 a[68:71], v[124:127], a[148:151], a[68:71]
    v_perm_b32 v193, v61, v57, s48
    v_perm_b32 v201, v61, v57, s49
    v_mfma_f32_16x16x32_bf16 a[68:71], v[120:123], a[144:147], a[68:71]
    s_waitcnt lgkmcnt(2)
    ds_read2_b32 v[16:17], v15 offset0:0 offset1:13
    v_mad_u32_u16 v4, v4, 16, v12 op_sel:[1,0,0,0]
    v_mfma_f32_16x16x32_bf16 a[36:39], v[120:123], a[136:139], a[36:39]
    v_perm_b32 v209, v62, v58, s48
    v_perm_b32 v217, v62, v58, s49
    v_mfma_f32_16x16x32_bf16 a[36:39], v[124:127], a[140:143], a[36:39]
    buffer_load_dwordx4 v[100:103], v3, s[16:19], s54 offen offset:2560
    v_mfma_f32_16x16x32_bf16 a[4:7], v[124:127], a[132:135], a[4:7]
    v_perm_b32 v225, v63, v59, s48
    v_perm_b32 v233, v63, v59, s49
    v_mfma_f32_16x16x32_bf16 a[4:7], v[120:123], a[128:131], a[4:7]
    s_waitcnt lgkmcnt(2)
    v_mad_u32_u16 v6, v6, 16, v12 op_sel:[1,0,0,0]
    v_mad_u32_u16 v5, v5, 16, v12 op_sel:[1,0,0,0]
    v_mfma_f32_16x16x32_bf16 v[28:31], a[192:195], a[200:203], 0
    ds_read_b128 a[160:163], v4 offset:0
    v_mad_u32_u16 v7, v7, 16, v12 op_sel:[1,0,0,0]
    v_mfma_f32_16x16x32_bf16 v[28:31], a[196:199], a[204:207], v[28:31]
    ds_read_b128 a[164:167], v4 offset:64
    v_mul_f32_e64 v20, v24, v36
    v_mfma_f32_16x16x32_bf16 a[8:11], v[128:131], a[128:131], a[8:11]
    s_waitcnt vmcnt(8)
    v_perm_b32 v178, v68, v64, s48
    v_perm_b32 v186, v68, v64, s49
    v_mfma_f32_16x16x32_bf16 a[8:11], v[132:135], a[132:135], a[8:11]
    buffer_load_dwordx4 v[104:107], v3, s[16:19], s54 offen offset:3072
    v_mfma_f32_16x16x32_bf16 a[40:43], v[132:135], a[140:143], a[40:43]
    v_perm_b32 v194, v69, v65, s48
    v_perm_b32 v202, v69, v65, s49
    v_mfma_f32_16x16x32_bf16 a[40:43], v[128:131], a[136:139], a[40:43]
    ds_read_b128 a[168:171], v6 offset:0
    v_fmac_f32 v20, v25, v37
    v_mfma_f32_16x16x32_bf16 a[72:75], v[128:131], a[144:147], a[72:75]
    v_perm_b32 v210, v70, v66, s48
    v_perm_b32 v218, v70, v66, s49
    v_mfma_f32_16x16x32_bf16 a[72:75], v[132:135], a[148:151], a[72:75]
    buffer_load_dwordx4 v[108:111], v3, s[16:19], s54 offen offset:3584
    v_mfma_f32_16x16x32_bf16 a[104:107], v[132:135], a[156:159], a[104:107]
    s_mov_b32 s54, s59
    v_perm_b32 v226, v71, v67, s48
    v_perm_b32 v234, v71, v67, s49
    v_mfma_f32_16x16x32_bf16 a[104:107], v[128:131], a[152:155], a[104:107]
    ds_read_b128 a[172:175], v6 offset:64
    v_fmac_f32 v20, v26, v38
    v_mfma_f32_16x16x32_bf16 v[32:35], a[200:203], a[200:203], 0
    ds_read_b128 a[176:179], v5 offset:0
    v_fmac_f32 v20, v27, v39
    v_mfma_f32_16x16x32_bf16 v[32:35], a[204:207], a[204:207], v[32:35]
    ds_read_b128 a[180:183], v5 offset:64
    v_fmac_f32 v20, v28, v40
    v_mfma_f32_16x16x32_bf16 a[108:111], v[136:139], a[152:155], a[108:111]
    s_waitcnt vmcnt(8)
    v_perm_b32 v179, v76, v72, s48
    v_perm_b32 v187, v76, v72, s49
    v_mfma_f32_16x16x32_bf16 a[108:111], v[140:143], a[156:159], a[108:111]
    buffer_load_dwordx4 v[48:51], v2, s[16:19], s54 offen offset:0
    v_mfma_f32_16x16x32_bf16 a[76:79], v[140:143], a[148:151], a[76:79]
    v_perm_b32 v195, v77, v73, s48
    v_perm_b32 v203, v77, v73, s49
    v_mfma_f32_16x16x32_bf16 a[76:79], v[136:139], a[144:147], a[76:79]
    ds_read_b128 a[184:187], v7 offset:0
    v_fmac_f32_e64 v20, v29, v41
    v_mfma_f32_16x16x32_bf16 a[44:47], v[136:139], a[136:139], a[44:47]
    v_perm_b32 v211, v78, v74, s48
    v_perm_b32 v219, v78, v74, s49
    v_mfma_f32_16x16x32_bf16 a[44:47], v[140:143], a[140:143], a[44:47]
    buffer_load_dwordx4 v[52:55], v2, s[16:19], s54 offen offset:512
    v_mfma_f32_16x16x32_bf16 a[12:15], v[140:143], a[132:135], a[12:15]
    v_perm_b32 v227, v79, v75, s48
    v_perm_b32 v235, v79, v75, s49
    v_mfma_f32_16x16x32_bf16 a[12:15], v[136:139], a[128:131], a[12:15]
    ds_read_b128 a[188:191], v7 offset:64
    v_fmac_f32 v20, v30, v42
    v_mfma_f32_16x16x32_bf16 a[16:19], v[144:147], a[128:131], a[16:19]
    s_waitcnt vmcnt(8)
    v_perm_b32 v180, v84, v80, s48
    v_perm_b32 v188, v84, v80, s49
    v_mfma_f32_16x16x32_bf16 a[16:19], v[148:151], a[132:135], a[16:19]
    buffer_load_dwordx4 v[56:59], v2, s[16:19], s54 offen offset:1024
    v_mfma_f32_16x16x32_bf16 a[48:51], v[148:151], a[140:143], a[48:51]
    v_perm_b32 v196, v85, v81, s48
    v_perm_b32 v204, v85, v81, s49
    v_mfma_f32_16x16x32_bf16 a[48:51], v[144:147], a[136:139], a[48:51]
    s_waitcnt lgkmcnt(8)
    v_mad_u32_u16 v16, v16, v22, v23 op_sel:[1,0,0,0]
    v_mad_u32_u16 v17, v17, v22, v23 op_sel:[1,0,0,0]
    v_mfma_f32_16x16x32_bf16 a[80:83], v[144:147], a[144:147], a[80:83]
    s_mov_b32 s43, s50
    v_perm_b32 v212, v86, v82, s48
    v_perm_b32 v220, v86, v82, s49
    v_mfma_f32_16x16x32_bf16 a[80:83], v[148:151], a[148:151], a[80:83]
    buffer_load_dwordx4 v[60:63], v2, s[16:19], s54 offen offset:1536
    v_mfma_f32_16x16x32_bf16 a[112:115], v[148:151], a[156:159], a[112:115]
    s_add_u32 s50, s50, 0x8000
    v_perm_b32 v228, v87, v83, s48
    v_perm_b32 v236, v87, v83, s49
    v_mfma_f32_16x16x32_bf16 a[112:115], v[144:147], a[152:155], a[112:115]
    ds_read_b128 a[192:195], v16 offset:0
    v_fmac_f32 v20, v31, v43
    v_mfma_f32_16x16x32_bf16 a[116:119], v[152:155], a[152:155], a[116:119]
    s_waitcnt vmcnt(8)
    v_perm_b32 v181, v92, v88, s48
    v_perm_b32 v189, v92, v88, s49
    v_mfma_f32_16x16x32_bf16 a[116:119], v[156:159], a[156:159], a[116:119]
    buffer_load_dwordx4 v[64:67], v2, s[16:19], s54 offen offset:2048
    v_mfma_f32_16x16x32_bf16 a[84:87], v[156:159], a[148:151], a[84:87]
    s_cmp_eq_u32 s50, s45
    v_perm_b32 v197, v93, v89, s48
    v_perm_b32 v205, v93, v89, s49
    v_mfma_f32_16x16x32_bf16 a[84:87], v[152:155], a[144:147], a[84:87]
    ds_read_b128 a[200:203], v17 offset:0
    v_fmac_f32 v20, v32, v44
    v_mfma_f32_16x16x32_bf16 a[52:55], v[152:155], a[136:139], a[52:55]
    s_cselect_b32 s50, s44, s50
    v_perm_b32 v213, v94, v90, s48
    v_perm_b32 v221, v94, v90, s49
    v_mfma_f32_16x16x32_bf16 a[52:55], v[156:159], a[140:143], a[52:55]
    buffer_load_dwordx4 v[68:71], v2, s[16:19], s54 offen offset:2560
    v_mfma_f32_16x16x32_bf16 a[20:23], v[156:159], a[132:135], a[20:23]
    s_cmp_eq_u32 s50, s46
    v_perm_b32 v229, v95, v91, s48
    v_perm_b32 v237, v95, v91, s49
    v_mfma_f32_16x16x32_bf16 a[20:23], v[152:155], a[128:131], a[20:23]
    ds_read_b128 a[196:199], v16 offset:64
    v_fmac_f32 v20, v33, v45
    v_mfma_f32_16x16x32_bf16 a[24:27], v[160:163], a[128:131], a[24:27]
    s_waitcnt vmcnt(8)
    v_perm_b32 v182, v100, v96, s48
    v_perm_b32 v190, v100, v96, s49
    v_mfma_f32_16x16x32_bf16 a[24:27], v[164:167], a[132:135], a[24:27]
    buffer_load_dwordx4 v[72:75], v2, s[16:19], s54 offen offset:3072
    v_mfma_f32_16x16x32_bf16 a[56:59], v[164:167], a[140:143], a[56:59]
    s_cselect_b32 s59, s55, s50
    v_perm_b32 v198, v101, v97, s48
    v_perm_b32 v206, v101, v97, s49
    v_mfma_f32_16x16x32_bf16 a[56:59], v[160:163], a[136:139], a[56:59]
    ds_read_b128 a[204:207], v17 offset:64
    v_fmac_f32 v20, v34, v46
    v_mfma_f32_16x16x32_bf16 a[88:91], v[160:163], a[144:147], a[88:91]
    v_perm_b32 v214, v102, v98, s48
    v_perm_b32 v222, v102, v98, s49
    v_mfma_f32_16x16x32_bf16 a[88:91], v[164:167], a[148:151], a[88:91]
    buffer_load_dwordx4 v[76:79], v2, s[16:19], s54 offen offset:3584
    v_mfma_f32_16x16x32_bf16 a[120:123], v[164:167], a[156:159], a[120:123]
    v_perm_b32 v230, v103, v99, s48
    v_perm_b32 v238, v103, v99, s49
    v_mfma_f32_16x16x32_bf16 a[120:123], v[160:163], a[152:155], a[120:123]
    v_fmac_f32 v20, v35, v47
    v_mfma_f32_16x16x32_bf16 a[124:127], v[168:171], a[152:155], a[124:127]
    s_waitcnt vmcnt(8)
    v_perm_b32 v183, v108, v104, s48
    v_perm_b32 v191, v108, v104, s49
    v_mfma_f32_16x16x32_bf16 a[124:127], v[172:175], a[156:159], a[124:127]
    buffer_load_dwordx4 v[80:83], v3, s[16:19], s54 offen offset:0
    v_mfma_f32_16x16x32_bf16 a[92:95], v[172:175], a[148:151], a[92:95]
    v_perm_b32 v199, v109, v105, s48
    v_perm_b32 v207, v109, v105, s49
    v_mfma_f32_16x16x32_bf16 a[92:95], v[168:171], a[144:147], a[92:95]
    v_add_f32_dpp v20, v20, v20 row_ror:8 row_mask:0xf bank_mask:0xf
    v_mfma_f32_16x16x32_bf16 a[60:63], v[168:171], a[136:139], a[60:63]
    v_perm_b32 v215, v110, v106, s48
    v_perm_b32 v223, v110, v106, s49
    v_mfma_f32_16x16x32_bf16 a[60:63], v[172:175], a[140:143], a[60:63]
    buffer_load_dwordx4 v[84:87], v3, s[16:19], s54 offen offset:512
    v_mfma_f32_16x16x32_bf16 a[28:31], v[172:175], a[132:135], a[28:31]
    v_perm_b32 v231, v111, v107, s48
    v_perm_b32 v239, v111, v107, s49
    v_mfma_f32_16x16x32_bf16 a[28:31], v[168:171], a[128:131], a[28:31]
    s_waitcnt lgkmcnt(4)
    v_add_f32_dpp v20, v20, v20 row_ror:4 row_mask:0xf bank_mask:0xf
    v_mfma_f32_16x16x32_bf16 a[0:3], v[176:179], a[160:163], a[0:3]
    s_waitcnt vmcnt(8)
    v_perm_b32 v112, v52, v48, s48
    v_perm_b32 v120, v52, v48, s49
    v_mfma_f32_16x16x32_bf16 a[0:3], v[180:183], a[164:167], a[0:3]
    buffer_load_dwordx4 v[88:91], v3, s[16:19], s54 offen offset:1024
    v_mfma_f32_16x16x32_bf16 a[32:35], v[180:183], a[172:175], a[32:35]
    s_lshr_b32 s57, s43, 13
    v_perm_b32 v128, v53, v49, s48
    v_perm_b32 v136, v53, v49, s49
    v_mfma_f32_16x16x32_bf16 a[32:35], v[176:179], a[168:171], a[32:35]
    s_waitcnt lgkmcnt(0)
    v_add_u32 v8, s57, v10
    v_add_u32 v9, s57, v11
    v_mfma_f32_16x16x32_bf16 a[64:67], v[176:179], a[176:179], a[64:67]
    v_perm_b32 v144, v54, v50, s48
    v_perm_b32 v152, v54, v50, s49
    v_mfma_f32_16x16x32_bf16 a[64:67], v[180:183], a[180:183], a[64:67]
    buffer_load_dwordx4 v[92:95], v3, s[16:19], s54 offen offset:1536
    v_mfma_f32_16x16x32_bf16 a[96:99], v[180:183], a[188:191], a[96:99]
    v_perm_b32 v160, v55, v51, s48
    v_perm_b32 v168, v55, v51, s49
    v_mfma_f32_16x16x32_bf16 a[96:99], v[176:179], a[184:187], a[96:99]
    ds_read2st64_b32 v[4:5], v8 offset0:0 offset1:13
    v_add_f32_dpp v20, v20, v20 row_ror:2 row_mask:0xf bank_mask:0xf
    v_mfma_f32_16x16x32_bf16 v[24:27], a[192:195], a[192:195], 0
    ds_read2st64_b32 v[6:7], v9 offset0:0 offset1:13
    v_add_f32_dpp v20, v20, v20 row_ror:1 row_mask:0xf bank_mask:0xf
    v_mfma_f32_16x16x32_bf16 v[24:27], a[196:199], a[196:199], v[24:27]
    ds_write_b32 v0, v20 offset:16
    v_mfma_f32_16x16x32_bf16 a[100:103], v[184:187], a[184:187], a[100:103]
    s_waitcnt vmcnt(8)
    v_perm_b32 v113, v60, v56, s48
    v_perm_b32 v121, v60, v56, s49
    v_mfma_f32_16x16x32_bf16 a[100:103], v[188:191], a[188:191], a[100:103]
    buffer_load_dwordx4 v[96:99], v3, s[16:19], s54 offen offset:2048
    v_mfma_f32_16x16x32_bf16 a[68:71], v[188:191], a[180:183], a[68:71]
    v_perm_b32 v129, v61, v57, s48
    v_perm_b32 v137, v61, v57, s49
    v_mfma_f32_16x16x32_bf16 a[68:71], v[184:187], a[176:179], a[68:71]
    s_waitcnt lgkmcnt(2)
    ds_read2_b32 v[16:17], v15 offset0:26 offset1:39
    v_mad_u32_u16 v4, v4, 16, v12 op_sel:[1,0,0,0]
    v_mfma_f32_16x16x32_bf16 a[36:39], v[184:187], a[168:171], a[36:39]
    v_perm_b32 v145, v62, v58, s48
    v_perm_b32 v153, v62, v58, s49
    v_mfma_f32_16x16x32_bf16 a[36:39], v[188:191], a[172:175], a[36:39]
    buffer_load_dwordx4 v[100:103], v3, s[16:19], s54 offen offset:2560
    v_mfma_f32_16x16x32_bf16 a[4:7], v[188:191], a[164:167], a[4:7]
    v_perm_b32 v161, v63, v59, s48
    v_perm_b32 v169, v63, v59, s49
    v_mfma_f32_16x16x32_bf16 a[4:7], v[184:187], a[160:163], a[4:7]
    s_waitcnt lgkmcnt(2)
    v_mad_u32_u16 v6, v6, 16, v12 op_sel:[1,0,0,0]
    v_mad_u32_u16 v5, v5, 16, v12 op_sel:[1,0,0,0]
    v_mfma_f32_16x16x32_bf16 v[28:31], a[192:195], a[200:203], 0
    ds_read_b128 a[128:131], v4 offset:0
    v_mad_u32_u16 v7, v7, 16, v12 op_sel:[1,0,0,0]
    v_mfma_f32_16x16x32_bf16 v[28:31], a[196:199], a[204:207], v[28:31]
    ds_read_b128 a[132:135], v4 offset:64
    v_mul_f32_e64 v20, v24, v36
    v_mfma_f32_16x16x32_bf16 a[8:11], v[192:195], a[160:163], a[8:11]
    s_waitcnt vmcnt(8)
    v_perm_b32 v114, v68, v64, s48
    v_perm_b32 v122, v68, v64, s49
    v_mfma_f32_16x16x32_bf16 a[8:11], v[196:199], a[164:167], a[8:11]
    buffer_load_dwordx4 v[104:107], v3, s[16:19], s54 offen offset:3072
    v_mfma_f32_16x16x32_bf16 a[40:43], v[196:199], a[172:175], a[40:43]
    v_perm_b32 v130, v69, v65, s48
    v_perm_b32 v138, v69, v65, s49
    v_mfma_f32_16x16x32_bf16 a[40:43], v[192:195], a[168:171], a[40:43]
    ds_read_b128 a[136:139], v6 offset:0
    v_fmac_f32 v20, v25, v37
    v_mfma_f32_16x16x32_bf16 a[72:75], v[192:195], a[176:179], a[72:75]
    v_perm_b32 v146, v70, v66, s48
    v_perm_b32 v154, v70, v66, s49
    v_mfma_f32_16x16x32_bf16 a[72:75], v[196:199], a[180:183], a[72:75]
    buffer_load_dwordx4 v[108:111], v3, s[16:19], s54 offen offset:3584
    v_mfma_f32_16x16x32_bf16 a[104:107], v[196:199], a[188:191], a[104:107]
    s_mov_b32 s54, s59
    v_perm_b32 v162, v71, v67, s48
    v_perm_b32 v170, v71, v67, s49
    v_mfma_f32_16x16x32_bf16 a[104:107], v[192:195], a[184:187], a[104:107]
    ds_read_b128 a[140:143], v6 offset:64
    v_fmac_f32 v20, v26, v38
    v_mfma_f32_16x16x32_bf16 v[32:35], a[200:203], a[200:203], 0
    ds_read_b128 a[144:147], v5 offset:0
    v_fmac_f32 v20, v27, v39
    v_mfma_f32_16x16x32_bf16 v[32:35], a[204:207], a[204:207], v[32:35]
    ds_read_b128 a[148:151], v5 offset:64
    v_fmac_f32 v20, v28, v40
    v_mfma_f32_16x16x32_bf16 a[108:111], v[200:203], a[184:187], a[108:111]
    s_waitcnt vmcnt(8)
    v_perm_b32 v115, v76, v72, s48
    v_perm_b32 v123, v76, v72, s49
    v_mfma_f32_16x16x32_bf16 a[108:111], v[204:207], a[188:191], a[108:111]
    buffer_load_dwordx4 v[48:51], v2, s[16:19], s54 offen offset:0
    v_mfma_f32_16x16x32_bf16 a[76:79], v[204:207], a[180:183], a[76:79]
    v_perm_b32 v131, v77, v73, s48
    v_perm_b32 v139, v77, v73, s49
    v_mfma_f32_16x16x32_bf16 a[76:79], v[200:203], a[176:179], a[76:79]
    ds_read_b128 a[152:155], v7 offset:0
    v_fmac_f32_e64 v20, v29, v41
    v_mfma_f32_16x16x32_bf16 a[44:47], v[200:203], a[168:171], a[44:47]
    v_perm_b32 v147, v78, v74, s48
    v_perm_b32 v155, v78, v74, s49
    v_mfma_f32_16x16x32_bf16 a[44:47], v[204:207], a[172:175], a[44:47]
    buffer_load_dwordx4 v[52:55], v2, s[16:19], s54 offen offset:512
    v_mfma_f32_16x16x32_bf16 a[12:15], v[204:207], a[164:167], a[12:15]
    v_perm_b32 v163, v79, v75, s48
    v_perm_b32 v171, v79, v75, s49
    v_mfma_f32_16x16x32_bf16 a[12:15], v[200:203], a[160:163], a[12:15]
    ds_read_b128 a[156:159], v7 offset:64
    v_fmac_f32 v20, v30, v42
    v_mfma_f32_16x16x32_bf16 a[16:19], v[208:211], a[160:163], a[16:19]
    s_waitcnt vmcnt(8)
    v_perm_b32 v116, v84, v80, s48
    v_perm_b32 v124, v84, v80, s49
    v_mfma_f32_16x16x32_bf16 a[16:19], v[212:215], a[164:167], a[16:19]
    buffer_load_dwordx4 v[56:59], v2, s[16:19], s54 offen offset:1024
    v_mfma_f32_16x16x32_bf16 a[48:51], v[212:215], a[172:175], a[48:51]
    v_perm_b32 v132, v85, v81, s48
    v_perm_b32 v140, v85, v81, s49
    v_mfma_f32_16x16x32_bf16 a[48:51], v[208:211], a[168:171], a[48:51]
    s_waitcnt lgkmcnt(8)
    v_mad_u32_u16 v16, v16, v22, v23 op_sel:[1,0,0,0]
    v_mad_u32_u16 v17, v17, v22, v23 op_sel:[1,0,0,0]
    v_mfma_f32_16x16x32_bf16 a[80:83], v[208:211], a[176:179], a[80:83]
    s_mov_b32 s43, s50
    v_perm_b32 v148, v86, v82, s48
    v_perm_b32 v156, v86, v82, s49
    v_mfma_f32_16x16x32_bf16 a[80:83], v[212:215], a[180:183], a[80:83]
    buffer_load_dwordx4 v[60:63], v2, s[16:19], s54 offen offset:1536
    v_mfma_f32_16x16x32_bf16 a[112:115], v[212:215], a[188:191], a[112:115]
    s_add_u32 s50, s50, 0x8000
    v_perm_b32 v164, v87, v83, s48
    v_perm_b32 v172, v87, v83, s49
    v_mfma_f32_16x16x32_bf16 a[112:115], v[208:211], a[184:187], a[112:115]
    ds_read_b128 a[192:195], v16 offset:0
    v_fmac_f32 v20, v31, v43
    v_mfma_f32_16x16x32_bf16 a[116:119], v[216:219], a[184:187], a[116:119]
    s_waitcnt vmcnt(8)
    v_perm_b32 v117, v92, v88, s48
    v_perm_b32 v125, v92, v88, s49
    v_mfma_f32_16x16x32_bf16 a[116:119], v[220:223], a[188:191], a[116:119]
    buffer_load_dwordx4 v[64:67], v2, s[16:19], s54 offen offset:2048
    v_mfma_f32_16x16x32_bf16 a[84:87], v[220:223], a[180:183], a[84:87]
    s_cmp_eq_u32 s50, s45
    v_perm_b32 v133, v93, v89, s48
    v_perm_b32 v141, v93, v89, s49
    v_mfma_f32_16x16x32_bf16 a[84:87], v[216:219], a[176:179], a[84:87]
    ds_read_b128 a[200:203], v17 offset:0
    v_fmac_f32 v20, v32, v44
    v_mfma_f32_16x16x32_bf16 a[52:55], v[216:219], a[168:171], a[52:55]
    s_cselect_b32 s50, s44, s50
    v_perm_b32 v149, v94, v90, s48
    v_perm_b32 v157, v94, v90, s49
    v_mfma_f32_16x16x32_bf16 a[52:55], v[220:223], a[172:175], a[52:55]
    buffer_load_dwordx4 v[68:71], v2, s[16:19], s54 offen offset:2560
    v_mfma_f32_16x16x32_bf16 a[20:23], v[220:223], a[164:167], a[20:23]
    s_cmp_eq_u32 s50, s46
    v_perm_b32 v165, v95, v91, s48
    v_perm_b32 v173, v95, v91, s49
    v_mfma_f32_16x16x32_bf16 a[20:23], v[216:219], a[160:163], a[20:23]
    ds_read_b128 a[196:199], v16 offset:64
    v_fmac_f32 v20, v33, v45
    v_mfma_f32_16x16x32_bf16 a[24:27], v[224:227], a[160:163], a[24:27]
    s_waitcnt vmcnt(8)
    v_perm_b32 v118, v100, v96, s48
    v_perm_b32 v126, v100, v96, s49
    v_mfma_f32_16x16x32_bf16 a[24:27], v[228:231], a[164:167], a[24:27]
    buffer_load_dwordx4 v[72:75], v2, s[16:19], s54 offen offset:3072
    v_mfma_f32_16x16x32_bf16 a[56:59], v[228:231], a[172:175], a[56:59]
    s_cselect_b32 s59, s55, s50
    v_perm_b32 v134, v101, v97, s48
    v_perm_b32 v142, v101, v97, s49
    v_mfma_f32_16x16x32_bf16 a[56:59], v[224:227], a[168:171], a[56:59]
    ds_read_b128 a[204:207], v17 offset:64
    v_fmac_f32 v20, v34, v46
    v_mfma_f32_16x16x32_bf16 a[88:91], v[224:227], a[176:179], a[88:91]
    v_perm_b32 v150, v102, v98, s48
    v_perm_b32 v158, v102, v98, s49
    v_mfma_f32_16x16x32_bf16 a[88:91], v[228:231], a[180:183], a[88:91]
    buffer_load_dwordx4 v[76:79], v2, s[16:19], s54 offen offset:3584
    v_mfma_f32_16x16x32_bf16 a[120:123], v[228:231], a[188:191], a[120:123]
    v_perm_b32 v166, v103, v99, s48
    v_perm_b32 v174, v103, v99, s49
    v_mfma_f32_16x16x32_bf16 a[120:123], v[224:227], a[184:187], a[120:123]
    v_fmac_f32_e64 v20, v35, v47
    v_add_u32 v15, 208, v15
    v_mfma_f32_16x16x32_bf16 a[124:127], v[232:235], a[184:187], a[124:127]
    s_waitcnt vmcnt(8)
    v_perm_b32 v119, v108, v104, s48
    v_perm_b32 v127, v108, v104, s49
    v_mfma_f32_16x16x32_bf16 a[124:127], v[236:239], a[188:191], a[124:127]
    buffer_load_dwordx4 v[80:83], v3, s[16:19], s54 offen offset:0
    v_mfma_f32_16x16x32_bf16 a[92:95], v[236:239], a[180:183], a[92:95]
    s_sub_u32 s56, s56, 1
    v_perm_b32 v135, v109, v105, s48
    v_perm_b32 v143, v109, v105, s49
    v_mfma_f32_16x16x32_bf16 a[92:95], v[232:235], a[176:179], a[92:95]
    v_add_f32_dpp v20, v20, v20 row_ror:8 row_mask:0xf bank_mask:0xf
    v_add_u32 v0, 32, v0
    v_mfma_f32_16x16x32_bf16 a[60:63], v[232:235], a[168:171], a[60:63]
    s_cmp_lg_u32 s56, 0
    v_perm_b32 v151, v110, v106, s48
    v_perm_b32 v159, v110, v106, s49
    v_mfma_f32_16x16x32_bf16 a[60:63], v[236:239], a[172:175], a[60:63]
    buffer_load_dwordx4 v[84:87], v3, s[16:19], s54 offen offset:512
    v_mfma_f32_16x16x32_bf16 a[28:31], v[236:239], a[164:167], a[28:31]
    v_perm_b32 v167, v111, v107, s48
    v_perm_b32 v175, v111, v107, s49
    v_mfma_f32_16x16x32_bf16 a[28:31], v[232:235], a[160:163], a[28:31]
    s_waitcnt lgkmcnt(4)
    v_add_f32_dpp v20, v20, v20 row_ror:4 row_mask:0xf bank_mask:0xf
    s_cbranch_scc1 L_loop
    v_mfma_f32_16x16x32_bf16 a[64:67], v[112:115], a[144:147], a[64:67]
    s_lshl_b32 s47, s40, 14
    v_lshlrev_b32 v9, 4, v1
    v_add_u32 v8, s47, v9
    v_mfma_f32_16x16x32_bf16 a[64:67], v[116:119], a[148:151], a[64:67]
    s_xor_b32 s51, s47, 16384
    v_add_f32_dpp v20, v20, v20 row_ror:2 row_mask:0xf bank_mask:0xf
    v_add_u32 v9, s51, v9
    v_mfma_f32_16x16x32_bf16 a[68:71], v[124:127], a[148:151], a[68:71]
    v_accvgpr_read_b32 v176, a0
    v_accvgpr_read_b32 v177, a1
    v_mfma_f32_16x16x32_bf16 a[68:71], v[120:123], a[144:147], a[68:71]
    s_waitcnt lgkmcnt(0)
    s_barrier
    v_add_f32_dpp v20, v20, v20 row_ror:1 row_mask:0xf bank_mask:0xf
    v_lshlrev_b32_e64 v3, 3, v1
    v_mfma_f32_16x16x32_bf16 a[72:75], v[128:131], a[144:147], a[72:75]
    ds_write_b32 v0, v20 offset:0
    v_mfma_f32_16x16x32_bf16 a[72:75], v[132:135], a[148:151], a[72:75]
    s_lshl_b32 s47, s40, 8
    ds_write_b128 v8, a[64:67] offset:0
    v_mfma_f32_16x16x32_bf16 a[76:79], v[140:143], a[148:151], a[76:79]
    s_add_u32 s47, s47, 156672
    v_accvgpr_read_b32 v178, a2
    v_accvgpr_read_b32 v179, a3
    v_mfma_f32_16x16x32_bf16 a[76:79], v[136:139], a[144:147], a[76:79]
    v_accvgpr_read_b32 v180, a4
    v_accvgpr_read_b32 v181, a5
    v_mfma_f32_16x16x32_bf16 a[80:83], v[144:147], a[144:147], a[80:83]
    ds_write_b128 v8, a[68:71] offset:1024
    v_mfma_f32_16x16x32_bf16 a[80:83], v[148:151], a[148:151], a[80:83]
    v_accvgpr_read_b32 v182, a6
    v_accvgpr_read_b32 v183, a7
    v_mfma_f32_16x16x32_bf16 a[84:87], v[156:159], a[148:151], a[84:87]
L_pt1:
    s_cbranch_execz L_ptb
    v_accvgpr_read_b32 v184, a8
    v_accvgpr_read_b32 v185, a9
    v_mfma_f32_16x16x32_bf16 a[84:87], v[152:155], a[144:147], a[84:87]
    ds_write_b128 v8, a[72:75] offset:2048
    v_mfma_f32_16x16x32_bf16 a[88:91], v[160:163], a[144:147], a[88:91]
    v_accvgpr_read_b32 v186, a10
    v_accvgpr_read_b32 v187, a11
    v_mfma_f32_16x16x32_bf16 a[88:91], v[164:167], a[148:151], a[88:91]
    v_accvgpr_read_b32 v188, a12
    v_accvgpr_read_b32 v189, a13
    v_mfma_f32_16x16x32_bf16 a[92:95], v[172:175], a[148:151], a[92:95]
    ds_write_b128 v8, a[76:79] offset:3072
    v_mfma_f32_16x16x32_bf16 a[92:95], v[168:171], a[144:147], a[92:95]
    buffer_load_dword v22, off, s[36:39], s95 sc1
    v_mfma_f32_16x16x32_bf16 a[96:99], v[112:115], a[152:155], a[96:99]
    v_accvgpr_read_b32 v190, a14
    v_accvgpr_read_b32 v191, a15
    v_mfma_f32_16x16x32_bf16 a[96:99], v[116:119], a[156:159], a[96:99]
    ds_write_b128 v8, a[80:83] offset:4096
    v_mfma_f32_16x16x32_bf16 a[100:103], v[124:127], a[156:159], a[100:103]
    buffer_load_dwordx2 v[20:21], v3, s[36:39], s93 offen sc1
    v_mfma_f32_16x16x32_bf16 a[100:103], v[120:123], a[152:155], a[100:103]
    v_accvgpr_read_b32 v192, a16
    v_accvgpr_read_b32 v193, a17
    v_mfma_f32_16x16x32_bf16 a[104:107], v[128:131], a[152:155], a[104:107]
    ds_write_b128 v8, a[84:87] offset:5120
    v_mfma_f32_16x16x32_bf16 a[104:107], v[132:135], a[156:159], a[104:107]
    v_accvgpr_read_b32 v194, a18
    v_accvgpr_read_b32 v195, a19
    v_mfma_f32_16x16x32_bf16 a[108:111], v[140:143], a[156:159], a[108:111]
    v_accvgpr_read_b32 v196, a20
    v_accvgpr_read_b32 v197, a21
    v_mfma_f32_16x16x32_bf16 a[108:111], v[136:139], a[152:155], a[108:111]
    ds_write_b128 v8, a[88:91] offset:6144
    v_mfma_f32_16x16x32_bf16 a[112:115], v[144:147], a[152:155], a[112:115]
    v_accvgpr_read_b32 v198, a22
    v_accvgpr_read_b32 v199, a23
    v_mfma_f32_16x16x32_bf16 a[112:115], v[148:151], a[156:159], a[112:115]
    v_accvgpr_read_b32 v200, a24
    v_accvgpr_read_b32 v201, a25
    v_mfma_f32_16x16x32_bf16 a[116:119], v[156:159], a[156:159], a[116:119]
    ds_write_b128 v8, a[92:95] offset:7168
    v_mfma_f32_16x16x32_bf16 a[116:119], v[152:155], a[152:155], a[116:119]
    v_accvgpr_read_b32 v202, a26
    v_accvgpr_read_b32 v203, a27
    v_mfma_f32_16x16x32_bf16 a[120:123], v[160:163], a[152:155], a[120:123]
    v_accvgpr_read_b32 v204, a28
    v_accvgpr_read_b32 v205, a29
    v_mfma_f32_16x16x32_bf16 a[120:123], v[164:167], a[156:159], a[120:123]
    ds_write_b128 v8, a[96:99] offset:8192
    v_mfma_f32_16x16x32_bf16 a[124:127], v[172:175], a[156:159], a[124:127]
    v_accvgpr_read_b32 v206, a30
    v_accvgpr_read_b32 v207, a31
    v_mfma_f32_16x16x32_bf16 a[124:127], v[168:171], a[152:155], a[124:127]
    v_accvgpr_read_b32 v208, a32
    v_accvgpr_read_b32 v209, a33
    v_mfma_f32_16x16x32_bf16 v[176:179], v[112:115], a[128:131], v[176:179]
    ds_write_b128 v8, a[100:103] offset:9216
    v_mfma_f32_16x16x32_bf16 v[176:179], v[116:119], a[132:135], v[176:179]
    v_accvgpr_read_b32 v210, a34
    v_accvgpr_read_b32 v211, a35
    v_mfma_f32_16x16x32_bf16 v[180:183], v[124:127], a[132:135], v[180:183]
    v_accvgpr_read_b32 v212, a36
    v_accvgpr_read_b32 v213, a37
    v_mfma_f32_16x16x32_bf16 v[180:183], v[120:123], a[128:131], v[180:183]
    ds_write_b128 v8, a[104:107] offset:10240
    v_mfma_f32_16x16x32_bf16 v[184:187], v[128:131], a[128:131], v[184:187]
    v_accvgpr_read_b32 v214, a38
    v_accvgpr_read_b32 v215, a39
    v_mfma_f32_16x16x32_bf16 v[184:187], v[132:135], a[132:135], v[184:187]
    v_accvgpr_read_b32 v216, a40
    v_accvgpr_read_b32 v217, a41
    v_mfma_f32_16x16x32_bf16 v[188:191], v[140:143], a[132:135], v[188:191]
    ds_write_b128 v8, a[108:111] offset:11264
    v_mfma_f32_16x16x32_bf16 v[188:191], v[136:139], a[128:131], v[188:191]
    v_accvgpr_read_b32 v218, a42
    v_accvgpr_read_b32 v219, a43
    v_mfma_f32_16x16x32_bf16 v[192:195], v[144:147], a[128:131], v[192:195]
    v_accvgpr_read_b32 v220, a44
    v_accvgpr_read_b32 v221, a45
    v_mfma_f32_16x16x32_bf16 v[192:195], v[148:151], a[132:135], v[192:195]
    ds_write_b128 v8, a[112:115] offset:12288
    v_mfma_f32_16x16x32_bf16 v[196:199], v[156:159], a[132:135], v[196:199]
    v_accvgpr_read_b32 v222, a46
    v_accvgpr_read_b32 v223, a47
    v_mfma_f32_16x16x32_bf16 v[196:199], v[152:155], a[128:131], v[196:199]
    v_accvgpr_read_b32 v224, a48
    v_accvgpr_read_b32 v225, a49
    v_mfma_f32_16x16x32_bf16 v[200:203], v[160:163], a[128:131], v[200:203]
    ds_write_b128 v8, a[116:119] offset:13312
    v_mfma_f32_16x16x32_bf16 v[200:203], v[164:167], a[132:135], v[200:203]
    v_accvgpr_read_b32 v226, a50
    v_accvgpr_read_b32 v227, a51
    v_mfma_f32_16x16x32_bf16 v[204:207], v[172:175], a[132:135], v[204:207]
    v_accvgpr_read_b32 v228, a52
    v_accvgpr_read_b32 v229, a53
    v_mfma_f32_16x16x32_bf16 v[204:207], v[168:171], a[128:131], v[204:207]
    ds_write_b128 v8, a[120:123] offset:14336
    v_mfma_f32_16x16x32_bf16 v[208:211], v[112:115], a[136:139], v[208:211]
    v_accvgpr_read_b32 v230, a54
    v_accvgpr_read_b32 v231, a55
    v_mfma_f32_16x16x32_bf16 v[208:211], v[116:119], a[140:143], v[208:211]
    v_accvgpr_read_b32 v232, a56
    v_accvgpr_read_b32 v233, a57
    v_mfma_f32_16x16x32_bf16 v[212:215], v[124:127], a[140:143], v[212:215]
    ds_write_b128 v8, a[124:127] offset:15360
    v_mfma_f32_16x16x32_bf16 v[212:215], v[120:123], a[136:139], v[212:215]
    ds_read_b128 v[24:27], v14 offset:512
    v_accvgpr_read_b32 v234, a58
    v_mfma_f32_16x16x32_bf16 v[216:219], v[128:131], a[136:139], v[216:219]
    ds_read_b128 v[28:31], v14 offset:528
    v_accvgpr_read_b32 v235, a59
    v_mfma_f32_16x16x32_bf16 v[216:219], v[132:135], a[140:143], v[216:219]
    ds_read_b128 v[32:35], v14 offset:544
    v_accvgpr_read_b32 v236, a60
    v_mfma_f32_16x16x32_bf16 v[220:223], v[140:143], a[140:143], v[220:223]
    ds_read_b128 v[36:39], v14 offset:560
    v_accvgpr_read_b32 v237, a61
    v_mfma_f32_16x16x32_bf16 v[220:223], v[136:139], a[136:139], v[220:223]
    s_waitcnt lgkmcnt(4)
    s_waitcnt vmcnt(2)
    s_barrier
    ds_read_b128 v[48:51], v9 offset:0
    v_accvgpr_read_b32 v238, a62
    v_mfma_f32_16x16x32_bf16 v[224:227], v[144:147], a[136:139], v[224:227]
    ds_read_b128 v[52:55], v9 offset:1024
    v_accvgpr_read_b32 v239, a63
    v_mfma_f32_16x16x32_bf16 v[224:227], v[148:151], a[140:143], v[224:227]
    ds_read_b128 v[56:59], v9 offset:2048
    v_and_b32 v2, 15, v1
    v_mfma_f32_16x16x32_bf16 v[228:231], v[156:159], a[140:143], v[228:231]
    ds_read_b128 v[60:63], v9 offset:3072
    v_cmp_gt_u32 vcc, 16, v1
    v_mfma_f32_16x16x32_bf16 v[228:231], v[152:155], a[136:139], v[228:231]
    ds_read_b128 v[64:67], v9 offset:4096
    v_lshlrev_b32 v11, 4, v2
    v_mfma_f32_16x16x32_bf16 v[232:235], v[160:163], a[136:139], v[232:235]
    ds_read_b128 v[68:71], v9 offset:5120
    v_lshlrev_b32_e64 v10, 1, v2
    v_mfma_f32_16x16x32_bf16 v[232:235], v[164:167], a[140:143], v[232:235]
    ds_read_b128 v[72:75], v9 offset:6144
    v_add_u32 v11, s47, v11
    v_mfma_f32_16x16x32_bf16 v[236:239], v[172:175], a[140:143], v[236:239]
    ds_read_b128 v[76:79], v9 offset:7168
    ds_read_b128 v[80:83], v9 offset:8192
    v_mfma_f32_16x16x32_bf16 v[236:239], v[168:171], a[136:139], v[236:239]
    ds_read_b128 v[84:87], v9 offset:9216
    ds_read_b128 v[88:91], v9 offset:10240
    v_cndmask_b32 v10, -1, v10, vcc
    s_waitcnt lgkmcnt(10)
    v_pk_add_f32 v[176:177], v[176:177], v[48:49]
    v_pk_add_f32 v[178:179], v[178:179], v[50:51]
    s_waitcnt lgkmcnt(9)
    v_pk_add_f32 v[180:181], v[180:181], v[52:53]
    v_pk_add_f32 v[182:183], v[182:183], v[54:55]
    v_pk_mul_f32 v[248:249], v[176:177], v[176:177]
    v_pk_mul_f32 v[250:251], v[178:179], v[178:179]
    ds_read_b128 v[40:43], v14 offset:576
    v_pk_mul_f32 v[252:253], v[180:181], v[180:181]
    v_pk_mul_f32 v[254:255], v[182:183], v[182:183]
    v_pk_fma_f32 v[248:249], v[248:249], s[52:53], s[52:53] op_sel:[0,0,1] op_sel_hi:[1,0,1]
    v_pk_fma_f32 v[250:251], v[250:251], s[52:53], s[52:53] op_sel:[0,0,1] op_sel_hi:[1,0,1]
    v_pk_fma_f32 v[252:253], v[252:253], s[52:53], s[52:53] op_sel:[0,0,1] op_sel_hi:[1,0,1]
    v_pk_fma_f32 v[254:255], v[254:255], s[52:53], s[52:53] op_sel:[0,0,1] op_sel_hi:[1,0,1]
    ds_read_b128 v[44:47], v14 offset:592
    v_pk_mul_f32 v[248:249], v[248:249], v[176:177]
    v_pk_mul_f32 v[250:251], v[250:251], v[178:179]
    v_pk_mul_f32 v[252:253], v[252:253], v[180:181]
    v_pk_mul_f32 v[254:255], v[254:255], v[182:183]
    v_exp_f32 v248, v248
    v_exp_f32 v249, v249
    ds_read_b128 v[92:95], v9 offset:11264
    v_exp_f32 v250, v250
    v_exp_f32 v251, v251
    v_exp_f32 v252, v252
    v_exp_f32 v253, v253
    v_exp_f32 v254, v254
    v_exp_f32 v255, v255
    ds_read_b128 v[16:19], v11
    v_pk_add_f32 v[248:249], v[248:249], 1.0 op_sel_hi:[1,0]
    v_pk_add_f32 v[250:251], v[250:251], 1.0 op_sel_hi:[1,0]
    v_pk_add_f32 v[252:253], v[252:253], 1.0 op_sel_hi:[1,0]
    v_pk_add_f32 v[254:255], v[254:255], 1.0 op_sel_hi:[1,0]
    v_rcp_f32 v248, v248
    v_rcp_f32 v249, v249
    ds_read_b128 v[96:99], v9 offset:12288
    v_rcp_f32_e64 v250, v250
    v_rcp_f32 v251, v251
    v_rcp_f32 v252, v252
    v_rcp_f32 v253, v253
    v_rcp_f32 v254, v254
    s_waitcnt lgkmcnt(12)
    v_rcp_f32 v255, v255
    ds_read_b128 v[100:103], v9 offset:13312
    v_pk_mul_f32 v[176:177], v[176:177], v[24:25]
    v_pk_mul_f32 v[178:179], v[178:179], v[26:27]
    v_pk_mul_f32 v[180:181], v[180:181], v[28:29]
    v_pk_mul_f32 v[182:183], v[182:183], v[30:31]
    v_pk_mul_f32 v[4:5], v[176:177], v[248:249]
    v_pk_mul_f32 v[6:7], v[178:179], v[250:251]
    ds_read_b128 v[104:107], v9 offset:14336
    v_pk_fma_f32 v[4:5], v[180:181], v[252:253], v[4:5]
    v_pk_fma_f32 v[6:7], v[182:183], v[254:255], v[6:7]
    v_pk_add_f32 v[184:185], v[184:185], v[56:57]
    v_pk_add_f32 v[186:187], v[186:187], v[58:59]
    v_pk_add_f32 v[188:189], v[188:189], v[60:61]
    v_pk_add_f32 v[190:191], v[190:191], v[62:63]
    v_pk_mul_f32 v[248:249], v[184:185], v[184:185]
    v_pk_mul_f32 v[250:251], v[186:187], v[186:187]
    ds_read_b128 v[108:111], v9 offset:15360
    v_pk_mul_f32 v[252:253], v[188:189], v[188:189]
    v_pk_mul_f32 v[254:255], v[190:191], v[190:191]
    v_pk_fma_f32 v[248:249], v[248:249], s[52:53], s[52:53] op_sel:[0,0,1] op_sel_hi:[1,0,1]
    v_pk_fma_f32 v[250:251], v[250:251], s[52:53], s[52:53] op_sel:[0,0,1] op_sel_hi:[1,0,1]
    v_pk_fma_f32 v[252:253], v[252:253], s[52:53], s[52:53] op_sel:[0,0,1] op_sel_hi:[1,0,1]
    v_pk_fma_f32 v[254:255], v[254:255], s[52:53], s[52:53] op_sel:[0,0,1] op_sel_hi:[1,0,1]
    v_pk_mul_f32 v[248:249], v[248:249], v[184:185]
    v_pk_mul_f32 v[250:251], v[250:251], v[186:187]
    v_pk_mul_f32 v[252:253], v[252:253], v[188:189]
    v_pk_mul_f32 v[254:255], v[254:255], v[190:191]
    v_exp_f32 v248, v248
    v_exp_f32 v249, v249
    v_exp_f32 v250, v250
    v_exp_f32 v251, v251
    v_exp_f32 v252, v252
    v_exp_f32 v253, v253
    v_exp_f32 v254, v254
    v_exp_f32 v255, v255
    v_pk_add_f32 v[248:249], v[248:249], 1.0 op_sel_hi:[1,0]
    v_pk_add_f32 v[250:251], v[250:251], 1.0 op_sel_hi:[1,0]
    v_pk_add_f32 v[252:253], v[252:253], 1.0 op_sel_hi:[1,0]
    v_pk_add_f32 v[254:255], v[254:255], 1.0 op_sel_hi:[1,0]
    v_rcp_f32_e64 v248, v248
    v_rcp_f32 v249, v249
    v_rcp_f32 v250, v250
    v_rcp_f32 v251, v251
    v_rcp_f32 v252, v252
    v_rcp_f32 v253, v253
    v_rcp_f32 v254, v254
    s_waitcnt lgkmcnt(13)
    v_rcp_f32 v255, v255
    v_pk_mul_f32 v[184:185], v[184:185], v[32:33]
    v_pk_mul_f32 v[186:187], v[186:187], v[34:35]
    v_pk_mul_f32 v[188:189], v[188:189], v[36:37]
    v_pk_mul_f32 v[190:191], v[190:191], v[38:39]
    v_pk_fma_f32 v[4:5], v[184:185], v[248:249], v[4:5]
    v_pk_fma_f32 v[6:7], v[186:187], v[250:251], v[6:7]
    v_pk_fma_f32 v[4:5], v[188:189], v[252:253], v[4:5]
    v_pk_fma_f32 v[6:7], v[190:191], v[254:255], v[6:7]
    v_pk_add_f32 v[192:193], v[192:193], v[64:65]
    v_pk_add_f32 v[194:195], v[194:195], v[66:67]
    v_pk_add_f32 v[196:197], v[196:197], v[68:69]
    v_pk_add_f32 v[198:199], v[198:199], v[70:71]
    v_pk_mul_f32 v[248:249], v[192:193], v[192:193]
    v_pk_mul_f32 v[250:251], v[194:195], v[194:195]
    v_pk_mul_f32 v[252:253], v[196:197], v[196:197]
    v_pk_mul_f32 v[254:255], v[198:199], v[198:199]
    v_pk_fma_f32 v[248:249], v[248:249], s[52:53], s[52:53] op_sel:[0,0,1] op_sel_hi:[1,0,1]
    v_pk_fma_f32 v[250:251], v[250:251], s[52:53], s[52:53] op_sel:[0,0,1] op_sel_hi:[1,0,1]
    v_pk_fma_f32 v[252:253], v[252:253], s[52:53], s[52:53] op_sel:[0,0,1] op_sel_hi:[1,0,1]
    v_pk_fma_f32 v[254:255], v[254:255], s[52:53], s[52:53] op_sel:[0,0,1] op_sel_hi:[1,0,1]
    v_pk_mul_f32 v[248:249], v[248:249], v[192:193]
    v_pk_mul_f32 v[250:251], v[250:251], v[194:195]
    v_pk_mul_f32 v[252:253], v[252:253], v[196:197]
    v_pk_mul_f32 v[254:255], v[254:255], v[198:199]
    v_exp_f32 v248, v248
    v_exp_f32 v249, v249
    v_exp_f32 v250, v250
    v_exp_f32 v251, v251
    v_exp_f32 v252, v252
    v_exp_f32 v253, v253
    v_exp_f32 v254, v254
    v_exp_f32 v255, v255
    v_pk_add_f32 v[248:249], v[248:249], 1.0 op_sel_hi:[1,0]
    v_pk_add_f32 v[250:251], v[250:251], 1.0 op_sel_hi:[1,0]
    v_pk_add_f32 v[252:253], v[252:253], 1.0 op_sel_hi:[1,0]
    v_pk_add_f32 v[254:255], v[254:255], 1.0 op_sel_hi:[1,0]
    v_rcp_f32_e64 v248, v248
    v_rcp_f32 v249, v249
    v_rcp_f32 v250, v250
    v_rcp_f32 v251, v251
    v_rcp_f32 v252, v252
    v_rcp_f32 v253, v253
    v_rcp_f32 v254, v254
    s_waitcnt lgkmcnt(0)
    v_rcp_f32 v255, v255
    v_pk_mul_f32 v[192:193], v[192:193], v[40:41]
    v_pk_mul_f32 v[194:195], v[194:195], v[42:43]
    v_pk_mul_f32 v[196:197], v[196:197], v[44:45]
    v_pk_mul_f32 v[198:199], v[198:199], v[46:47]
    v_pk_fma_f32 v[4:5], v[192:193], v[248:249], v[4:5]
    v_pk_fma_f32 v[6:7], v[194:195], v[250:251], v[6:7]
    v_pk_fma_f32 v[4:5], v[196:197], v[252:253], v[4:5]
    v_pk_fma_f32 v[6:7], v[198:199], v[254:255], v[6:7]
    s_waitcnt vmcnt(0)
    v_readfirstlane_b32 s97, v22
    v_pk_add_f32 v[200:201], v[200:201], v[72:73]
    v_pk_add_f32 v[202:203], v[202:203], v[74:75]
    v_pk_add_f32 v[204:205], v[204:205], v[76:77]
    v_pk_add_f32 v[206:207], v[206:207], v[78:79]
    v_pk_mul_f32 v[248:249], v[200:201], v[200:201]
    v_pk_mul_f32 v[250:251], v[202:203], v[202:203]
    v_pk_mul_f32 v[252:253], v[204:205], v[204:205]
    v_pk_mul_f32 v[254:255], v[206:207], v[206:207]
    v_pk_fma_f32 v[248:249], v[248:249], s[52:53], s[52:53] op_sel:[0,0,1] op_sel_hi:[1,0,1]
    v_pk_fma_f32 v[250:251], v[250:251], s[52:53], s[52:53] op_sel:[0,0,1] op_sel_hi:[1,0,1]
    v_pk_fma_f32 v[252:253], v[252:253], s[52:53], s[52:53] op_sel:[0,0,1] op_sel_hi:[1,0,1]
    v_pk_fma_f32 v[254:255], v[254:255], s[52:53], s[52:53] op_sel:[0,0,1] op_sel_hi:[1,0,1]
    v_pk_mul_f32 v[248:249], v[248:249], v[200:201]
    v_pk_mul_f32 v[250:251], v[250:251], v[202:203]
    v_pk_mul_f32 v[252:253], v[252:253], v[204:205]
    v_pk_mul_f32 v[254:255], v[254:255], v[206:207]
    v_exp_f32 v248, v248
    v_exp_f32 v249, v249
    v_exp_f32 v250, v250
    v_exp_f32 v251, v251
    v_exp_f32 v252, v252
    v_exp_f32 v253, v253
    v_exp_f32 v254, v254
    v_exp_f32 v255, v255
    v_pk_add_f32 v[248:249], v[248:249], 1.0 op_sel_hi:[1,0]
    v_pk_add_f32 v[250:251], v[250:251], 1.0 op_sel_hi:[1,0]
    v_pk_add_f32 v[252:253], v[252:253], 1.0 op_sel_hi:[1,0]
    v_pk_add_f32 v[254:255], v[254:255], 1.0 op_sel_hi:[1,0]
    v_rcp_f32 v248, v248
    v_rcp_f32 v249, v249
    v_rcp_f32 v250, v250
    v_rcp_f32 v251, v251
    v_rcp_f32 v252, v252
    v_rcp_f32 v253, v253
    v_rcp_f32 v254, v254
    v_rcp_f32 v255, v255
    v_pk_mul_f32 v[200:201], v[200:201], v[240:241]
    v_pk_mul_f32 v[202:203], v[202:203], v[242:243]
    v_pk_mul_f32 v[204:205], v[204:205], v[244:245]
    v_pk_mul_f32 v[206:207], v[206:207], v[246:247]
    v_pk_fma_f32 v[4:5], v[200:201], v[248:249], v[4:5]
    v_pk_fma_f32 v[6:7], v[202:203], v[250:251], v[6:7]
    v_pk_fma_f32 v[4:5], v[204:205], v[252:253], v[4:5]
    v_pk_fma_f32 v[6:7], v[206:207], v[254:255], v[6:7]
    s_add_u32 s97, s97, 8
    s_and_b32 s97, s97, -8
    s_or_b32 s47, s97, s96
    v_pk_add_f32 v[4:5], v[4:5], v[6:7]
    v_mov_b32 v9, s47
    v_add_f32_e64 v8, v4, v5
    buffer_store_dwordx2 v[8:9], v3, s[36:39], s94 offen
    v_pk_add_f32 v[208:209], v[208:209], v[80:81]
    v_pk_add_f32 v[210:211], v[210:211], v[82:83]
    v_pk_add_f32 v[212:213], v[212:213], v[84:85]
    v_pk_add_f32 v[214:215], v[214:215], v[86:87]
    v_pk_mul_f32 v[248:249], v[208:209], v[208:209]
    v_pk_mul_f32 v[250:251], v[210:211], v[210:211]
    v_pk_mul_f32 v[252:253], v[212:213], v[212:213]
    v_pk_mul_f32 v[254:255], v[214:215], v[214:215]
    v_pk_fma_f32 v[248:249], v[248:249], s[52:53], s[52:53] op_sel:[0,0,1] op_sel_hi:[1,0,1]
    v_pk_fma_f32 v[250:251], v[250:251], s[52:53], s[52:53] op_sel:[0,0,1] op_sel_hi:[1,0,1]
    v_pk_fma_f32 v[252:253], v[252:253], s[52:53], s[52:53] op_sel:[0,0,1] op_sel_hi:[1,0,1]
    v_pk_fma_f32 v[254:255], v[254:255], s[52:53], s[52:53] op_sel:[0,0,1] op_sel_hi:[1,0,1]
    v_pk_mul_f32 v[248:249], v[248:249], v[208:209]
    v_pk_mul_f32 v[250:251], v[250:251], v[210:211]
    v_pk_mul_f32 v[252:253], v[252:253], v[212:213]
    v_pk_mul_f32 v[254:255], v[254:255], v[214:215]
    v_exp_f32 v248, v248
    v_exp_f32 v249, v249
    v_exp_f32 v250, v250
    v_exp_f32 v251, v251
    v_exp_f32 v252, v252
    v_exp_f32 v253, v253
    v_exp_f32 v254, v254
    v_exp_f32 v255, v255
    v_pk_add_f32 v[248:249], v[248:249], 1.0 op_sel_hi:[1,0]
    v_pk_add_f32 v[250:251], v[250:251], 1.0 op_sel_hi:[1,0]
    v_pk_add_f32 v[252:253], v[252:253], 1.0 op_sel_hi:[1,0]
    v_pk_add_f32 v[254:255], v[254:255], 1.0 op_sel_hi:[1,0]
    v_rcp_f32 v248, v248
    v_rcp_f32 v249, v249
    v_rcp_f32 v250, v250
    v_rcp_f32 v251, v251
    v_rcp_f32 v252, v252
    v_rcp_f32 v253, v253
    v_rcp_f32 v254, v254
    v_rcp_f32 v255, v255
    v_pk_mul_f32 v[208:209], v[208:209], v[24:25]
    v_pk_mul_f32 v[210:211], v[210:211], v[26:27]
    v_pk_mul_f32 v[212:213], v[212:213], v[28:29]
    v_pk_mul_f32 v[214:215], v[214:215], v[30:31]
    v_pk_mul_f32 v[4:5], v[208:209], v[248:249]
    v_pk_mul_f32 v[6:7], v[210:211], v[250:251]
    v_pk_fma_f32 v[4:5], v[212:213], v[252:253], v[4:5]
    v_pk_fma_f32 v[6:7], v[214:215], v[254:255], v[6:7]
    v_pk_add_f32 v[216:217], v[216:217], v[88:89]
    v_pk_add_f32 v[218:219], v[218:219], v[90:91]
    v_pk_add_f32 v[220:221], v[220:221], v[92:93]
    v_pk_add_f32 v[222:223], v[222:223], v[94:95]
    v_pk_mul_f32 v[248:249], v[216:217], v[216:217]
    v_pk_mul_f32 v[250:251], v[218:219], v[218:219]
    v_pk_mul_f32 v[252:253], v[220:221], v[220:221]
    v_pk_mul_f32 v[254:255], v[222:223], v[222:223]
    v_pk_fma_f32 v[248:249], v[248:249], s[52:53], s[52:53] op_sel:[0,0,1] op_sel_hi:[1,0,1]
    v_pk_fma_f32 v[250:251], v[250:251], s[52:53], s[52:53] op_sel:[0,0,1] op_sel_hi:[1,0,1]
    v_pk_fma_f32 v[252:253], v[252:253], s[52:53], s[52:53] op_sel:[0,0,1] op_sel_hi:[1,0,1]
    v_pk_fma_f32 v[254:255], v[254:255], s[52:53], s[52:53] op_sel:[0,0,1] op_sel_hi:[1,0,1]
    v_pk_mul_f32 v[248:249], v[248:249], v[216:217]
    v_pk_mul_f32 v[250:251], v[250:251], v[218:219]
    v_pk_mul_f32 v[252:253], v[252:253], v[220:221]
    v_pk_mul_f32 v[254:255], v[254:255], v[222:223]
    v_exp_f32 v248, v248
    v_exp_f32 v249, v249
    v_exp_f32 v250, v250
    v_exp_f32 v251, v251
    v_exp_f32 v252, v252
    v_exp_f32 v253, v253
    v_exp_f32 v254, v254
    v_exp_f32 v255, v255
    v_pk_add_f32 v[248:249], v[248:249], 1.0 op_sel_hi:[1,0]
    v_pk_add_f32 v[250:251], v[250:251], 1.0 op_sel_hi:[1,0]
    v_pk_add_f32 v[252:253], v[252:253], 1.0 op_sel_hi:[1,0]
    v_pk_add_f32 v[254:255], v[254:255], 1.0 op_sel_hi:[1,0]
    v_rcp_f32 v248, v248
    v_rcp_f32 v249, v249
    v_rcp_f32 v250, v250
    v_rcp_f32 v251, v251
    v_rcp_f32 v252, v252
    v_rcp_f32 v253, v253
    v_rcp_f32 v254, v254
    v_rcp_f32 v255, v255
    v_pk_add_f32 v[16:17], v[16:17], v[18:19]
    v_add_f32 v16, v16, v13
    v_add_f32 v13, v16, v17
    v_or_b32 v11, s92, v1
    v_lshlrev_b32 v11, 26, v11
    v_pk_mul_f32 v[216:217], v[216:217], v[32:33]
    v_pk_mul_f32 v[218:219], v[218:219], v[34:35]
    v_pk_mul_f32 v[220:221], v[220:221], v[36:37]
    v_pk_mul_f32 v[222:223], v[222:223], v[38:39]
    v_pk_fma_f32 v[4:5], v[216:217], v[248:249], v[4:5]
    v_pk_fma_f32 v[6:7], v[218:219], v[250:251], v[6:7]
    v_pk_fma_f32 v[4:5], v[220:221], v[252:253], v[4:5]
    v_pk_fma_f32 v[6:7], v[222:223], v[254:255], v[6:7]
    v_pk_add_f32 v[224:225], v[224:225], v[96:97]
    v_pk_add_f32 v[226:227], v[226:227], v[98:99]
    v_pk_add_f32 v[228:229], v[228:229], v[100:101]
    v_pk_add_f32 v[230:231], v[230:231], v[102:103]
    v_pk_mul_f32 v[248:249], v[224:225], v[224:225]
    v_pk_mul_f32 v[250:251], v[226:227], v[226:227]
    v_pk_mul_f32 v[252:253], v[228:229], v[228:229]
    v_pk_mul_f32 v[254:255], v[230:231], v[230:231]
    v_pk_fma_f32 v[248:249], v[248:249], s[52:53], s[52:53] op_sel:[0,0,1] op_sel_hi:[1,0,1]
    v_pk_fma_f32 v[250:251], v[250:251], s[52:53], s[52:53] op_sel:[0,0,1] op_sel_hi:[1,0,1]
    v_pk_fma_f32 v[252:253], v[252:253], s[52:53], s[52:53] op_sel:[0,0,1] op_sel_hi:[1,0,1]
    v_pk_fma_f32 v[254:255], v[254:255], s[52:53], s[52:53] op_sel:[0,0,1] op_sel_hi:[1,0,1]
    v_pk_mul_f32 v[248:249], v[248:249], v[224:225]
    v_pk_mul_f32 v[250:251], v[250:251], v[226:227]
    v_pk_mul_f32 v[252:253], v[252:253], v[228:229]
    v_pk_mul_f32 v[254:255], v[254:255], v[230:231]
    v_exp_f32 v248, v248
    v_exp_f32 v249, v249
    v_exp_f32 v250, v250
    v_exp_f32 v251, v251
    v_exp_f32 v252, v252
    v_exp_f32 v253, v253
    v_exp_f32 v254, v254
    v_exp_f32 v255, v255
    buffer_load_dwordx2 v[20:21], v3, s[36:39], s93 offen sc1
    v_pk_add_f32 v[248:249], v[248:249], 1.0 op_sel_hi:[1,0]
    v_pk_add_f32 v[250:251], v[250:251], 1.0 op_sel_hi:[1,0]
    v_pk_add_f32 v[252:253], v[252:253], 1.0 op_sel_hi:[1,0]
    v_pk_add_f32 v[254:255], v[254:255], 1.0 op_sel_hi:[1,0]
    v_rcp_f32 v248, v248
    v_rcp_f32 v249, v249
    v_rcp_f32 v250, v250
    v_rcp_f32 v251, v251
    v_rcp_f32 v252, v252
    v_rcp_f32 v253, v253
    v_rcp_f32 v254, v254
    v_rcp_f32 v255, v255
    v_pk_mul_f32 v[224:225], v[224:225], v[40:41]
    v_pk_mul_f32 v[226:227], v[226:227], v[42:43]
    v_pk_mul_f32 v[228:229], v[228:229], v[44:45]
    v_pk_mul_f32 v[230:231], v[230:231], v[46:47]
    v_pk_fma_f32 v[4:5], v[224:225], v[248:249], v[4:5]
    v_pk_fma_f32 v[6:7], v[226:227], v[250:251], v[6:7]
    v_pk_fma_f32 v[4:5], v[228:229], v[252:253], v[4:5]
    v_pk_fma_f32 v[6:7], v[230:231], v[254:255], v[6:7]
    v_pk_add_f32 v[232:233], v[232:233], v[104:105]
    v_pk_add_f32 v[234:235], v[234:235], v[106:107]
    v_pk_add_f32 v[236:237], v[236:237], v[108:109]
    v_pk_add_f32 v[238:239], v[238:239], v[110:111]
    v_pk_mul_f32 v[248:249], v[232:233], v[232:233]
    v_pk_mul_f32 v[250:251], v[234:235], v[234:235]
    v_pk_mul_f32 v[252:253], v[236:237], v[236:237]
    v_pk_mul_f32 v[254:255], v[238:239], v[238:239]
    v_pk_fma_f32 v[248:249], v[248:249], s[52:53], s[52:53] op_sel:[0,0,1] op_sel_hi:[1,0,1]
    v_pk_fma_f32 v[250:251], v[250:251], s[52:53], s[52:53] op_sel:[0,0,1] op_sel_hi:[1,0,1]
    v_pk_fma_f32 v[252:253], v[252:253], s[52:53], s[52:53] op_sel:[0,0,1] op_sel_hi:[1,0,1]
    v_pk_fma_f32 v[254:255], v[254:255], s[52:53], s[52:53] op_sel:[0,0,1] op_sel_hi:[1,0,1]
    v_pk_mul_f32 v[248:249], v[248:249], v[232:233]
    v_pk_mul_f32 v[250:251], v[250:251], v[234:235]
    v_pk_mul_f32 v[252:253], v[252:253], v[236:237]
    v_pk_mul_f32 v[254:255], v[254:255], v[238:239]
    v_exp_f32 v248, v248
    v_exp_f32 v249, v249
    v_exp_f32 v250, v250
    v_exp_f32 v251, v251
    v_exp_f32 v252, v252
    v_exp_f32 v253, v253
    v_exp_f32 v254, v254
    v_exp_f32 v255, v255
    v_pk_add_f32 v[248:249], v[248:249], 1.0 op_sel_hi:[1,0]
    v_pk_add_f32 v[250:251], v[250:251], 1.0 op_sel_hi:[1,0]
    v_pk_add_f32 v[252:253], v[252:253], 1.0 op_sel_hi:[1,0]
    v_pk_add_f32 v[254:255], v[254:255], 1.0 op_sel_hi:[1,0]
    v_rcp_f32 v248, v248
    v_rcp_f32 v249, v249
    v_rcp_f32 v250, v250
    v_rcp_f32 v251, v251
    v_rcp_f32 v252, v252
    v_rcp_f32 v253, v253
    v_rcp_f32 v254, v254
    v_rcp_f32 v255, v255
    v_pk_mul_f32 v[232:233], v[232:233], v[240:241]
    v_pk_mul_f32 v[234:235], v[234:235], v[242:243]
    v_pk_mul_f32 v[236:237], v[236:237], v[244:245]
    v_pk_mul_f32 v[238:239], v[238:239], v[246:247]
    v_pk_fma_f32 v[4:5], v[232:233], v[248:249], v[4:5]
    v_pk_fma_f32 v[6:7], v[234:235], v[250:251], v[6:7]
    v_pk_fma_f32 v[4:5], v[236:237], v[252:253], v[4:5]
    v_pk_fma_f32 v[6:7], v[238:239], v[254:255], v[6:7]
    v_pk_add_f32 v[4:5], v[4:5], v[6:7]
    v_add_f32 v6, v4, v5
L_poll:
    s_waitcnt vmcnt(0)
    v_xor_b32 v22, s97, v21
    v_add_f32 v7, v6, v20
    v_cmp_gt_u32 vcc, 8, v22
    v_mov_b32 v23, v7
    s_cmp_eq_u64 vcc, exec
    s_cbranch_scc0 L_retry
L_got:
    v_permlane32_swap_b32 v7, v23
    v_add_f32 v7, v7, v23
    v_mov_b32 v23, v7
    v_readfirstlane_b32 s47, v22
    v_mov_b32 v21, s97
    v_permlane16_swap_b32 v7, v23
    v_add_f32 v7, v7, v13
    v_add_f32 v4, v7, v23
    v_cvt_pk_bf16_f32 v4, v4, v4
    buffer_store_short v4, v10, s[32:35], s58 offen
    buffer_store_dword v21, v11, s[36:39], s95 offen
    s_cmp_eq_u32 s47, s96
    s_cbranch_scc1 L_fin
    buffer_wbl2 sc1
    s_branch L_fin
L_retry:
    s_add_u32 s56, s56, 1
    s_cmp_lg_u32 s56, 8
    s_cbranch_scc1 L_again
    buffer_wbl2 sc1
L_again:
    s_cmp_ge_u32 s56, 0x40000
    s_cbranch_scc1 L_got
    buffer_load_dwordx2 v[20:21], v3, s[36:39], s93 offen sc1
    s_branch L_poll
L_fin:
L_pt2:
    s_cbranch_execz L_ptb
L_end:
    s_endpgm
.p2align 12
.section .rodata,"a"
.p2align 6
.amdhsa_kernel standalone__deep_cross_pnn__recsys_kernel
  .amdhsa_next_free_vgpr 512
  .amdhsa_next_free_sgpr 102
  .amdhsa_accum_offset 256
  .amdhsa_group_segment_fixed_size 0
  .amdhsa_kernarg_size 80
  .amdhsa_user_sgpr_count 2
  .amdhsa_user_sgpr_kernarg_segment_ptr 1
  .amdhsa_system_sgpr_workgroup_id_x 1
.end_amdhsa_kernel
```
